```python
import torch

def _softmax(x, axis=-1):
    return torch.softmax(x, dim=axis)
def _gelu(x):
    return torch.nn.functional.gelu(x, approximate="tanh")
def _silu(x):
    return torch.nn.functional.silu(x)
def _sigmoid(x):
    return torch.sigmoid(x)
def _layernorm(x, axis=-1, eps=1e-5):
    m = x.mean(dim=axis, keepdim=True)
    v = x.var(dim=axis, keepdim=True, unbiased=False)
    return (x - m) / torch.sqrt(v + eps)
def _scatter_add(tgt, idx, src, axis=0):
    return tgt.clone().index_add_(axis, idx, src)
def _segment_sum(src, seg, n):
    out = torch.zeros((n,) + src.shape[1:], dtype=src.dtype)
    return out.index_add_(0, seg, src)
def _pad(x, pw):
    flat = tuple(v for pair in reversed(pw) for v in pair)
    return torch.nn.functional.pad(x, flat)

kernel_name = 'concat_heads__ssm_conv_s4d__softmax_full_mha__prompt'

def setup_inputs():

    _w = (lambda a: (lambda t: t.to(torch.bfloat16) if t.is_floating_point() else t)(torch.as_tensor(a)))
    def _A_setup():
        Bsz, L, D, N = 1, 2048, 512, 128
        return {
            "u": _w((lambda *s: torch.randn(*s, dtype=torch.bfloat16) * 0.05)(Bsz, L, D)),
            "log_A_real": _w((lambda *s: torch.randn(*s, dtype=torch.bfloat16) * 6.4)(D, N) * 0.5),
            "A_imag": _w((lambda *s: torch.randn(*s, dtype=torch.bfloat16) * 0.1)(D, N) * 3.14),
            "C_real": _w((lambda *s: torch.randn(*s, dtype=torch.bfloat16) * 0.4)(D, N) / N ** 0.5),
            "C_imag": _w((lambda *s: torch.randn(*s, dtype=torch.bfloat16) * 0.4)(D, N) / N ** 0.5),
            "log_dt": _w((lambda *s: torch.randn(*s, dtype=torch.bfloat16) * 0.1)(D) * 0.5 - 4.0),
            "D_skip": _w((lambda *s: torch.randn(*s, dtype=torch.bfloat16) * 0.1)(D)),
        }
    _A_in = _A_setup()

    def _B_setup():
        B, S, D = 1, 2048, 512
        return {
            "x": _w((lambda *s: torch.randn(*s, dtype=torch.bfloat16) * 0.2)(B, S, D)),
            "wqkv": _w((lambda *s: torch.randn(*s, dtype=torch.bfloat16) * 0.2)(D, 3 * D)),
            "wo": _w((lambda *s: torch.randn(*s, dtype=torch.bfloat16) * 0.05)(D, D)),
        }
    _B_in = _B_setup()

    return {
        "A_u": _A_in["u"],
        "A_log_A_real": _A_in["log_A_real"],
        "A_A_imag": _A_in["A_imag"],
        "A_C_real": _A_in["C_real"],
        "A_C_imag": _A_in["C_imag"],
        "A_log_dt": _A_in["log_dt"],
        "A_D_skip": _A_in["D_skip"],
        "B_x": _B_in["x"],
        "B_wqkv": _B_in["wqkv"],
        "B_wo": _B_in["wo"],
    }

def reference(A_u, A_log_A_real, A_A_imag, A_C_real, A_C_imag, A_log_dt, A_D_skip, B_x, B_wqkv, B_wo):
    def _A_ref(u, log_A_real, A_imag, C_real, C_imag, log_dt, D_skip):
        L = u.shape[1]
        dt = torch.exp(log_dt)
        A = -torch.exp(log_A_real) + 1j * A_imag
        C = (C_real + 1j * C_imag) * dt[:, None]
        pos = (lambda x, dt: x.to(dt))(torch.arange(L), log_dt.dtype)
        P = torch.exp((A * dt[:, None])[:, :, None] * pos[None, None, :])
        K = 2.0 * torch.einsum("dn,dnl->dl", C, P).real
        L2 = 2 * L
        u_t = (lambda x, *d: x.permute(*d))(u, 0, 2, 1)
        Kf = (lambda x, *a, **k: torch.fft.rfft(x.float(), *a, **k))(K, L2)
        Uf = (lambda x, *a, **k: torch.fft.rfft(x.float(), *a, **k))(u_t, L2)
        y = (lambda x, *a, **k: torch.fft.irfft(x, *a, **k).to(torch.bfloat16))(Uf * Kf[None, :, :], L2)[:, :, :L]
        y = (lambda x, *d: x.permute(*d))(y, 0, 2, 1)
        return y + u * D_skip[None, None, :]

    def _B_ref(x, wqkv, wo):
        B, S, D = x.shape
        H = 32; Dh = D // H
        qkv = (lambda x, *d: x.permute(*d))((x @ wqkv).reshape(B, S, 3, H, Dh), 2, 0, 3, 1, 4)
        q, k, v = qkv[0], qkv[1], qkv[2]
        scale = Dh ** -0.5
        scores = torch.einsum("bhqd,bhkd->bhqk", q, k) * scale
        p = _softmax(scores, axis=-1)
        o = torch.einsum("bhqk,bhkd->bhqd", p, v)
        return (lambda x, *d: x.permute(*d))(o, 0, 2, 1, 3).reshape(B, S, D) @ wo

    a = _A_ref(A_u, A_log_A_real, A_A_imag, A_C_real, A_C_imag, A_log_dt, A_D_skip)
    b = _B_ref(B_x, B_wqkv, B_wo)
    return torch.concatenate([a, b], axis=-1)
```

```asm
; @launch kernel=qkv_kernel grid=(256,1,1) block=(256,1,1) lds=163840
; @launch kernel=mid_kernel grid=(512,1,1) block=(512,1,1) lds=73728
; @launch kernel=fin_kernel grid=(256,1,1) block=(256,1,1) lds=65536
.amdgcn_target "amdgcn-amd-amdhsa--gfx950"
.text
.globl qkv_kernel
.p2align 8
.type qkv_kernel,@function
qkv_kernel:
    s_cmp_ge_u32 s2, 256
    s_cbranch_scc1 L_qkv_end_1
    s_load_dwordx2 s[4:5], s[0:1], 56
    s_load_dwordx2 s[6:7], s[0:1], 64
    s_load_dwordx2 s[8:9], s[0:1], 96
    s_and_b32 s13, s2, 7
    s_lshl_b32 s13, s13, 1
    s_bfe_u32 s10, s2, 0x10003
    s_add_u32 s10, s10, s13
    s_lshr_b32 s11, s2, 4
    v_mov_b32 v108, v0
    v_and_b32 v109, 63, v108
    v_lshrrev_b32 v114, 6, v108
    s_nop 0
    v_readfirstlane_b32 s12, v114
    s_waitcnt lgkmcnt(0)
    s_mov_b32 s16, s4
    s_and_b32 s17, s5, 0xffff
    s_mov_b32 s18, 2097152
    s_mov_b32 s19, 0x00020000
    s_mov_b32 s20, s6
    s_and_b32 s21, s7, 0xffff
    s_mov_b32 s22, 1572864
    s_mov_b32 s23, 0x00020000
    s_mov_b32 s24, s8
    s_and_b32 s25, s9, 0xffff
    s_mov_b32 s26, 12582912
    s_mov_b32 s27, 0x00020000
    s_mul_i32 s14, s11, 192
    s_lshl_b32 s13, s10, 7
    s_lshl_b32 s15, s12, 5
    s_add_u32 s13, s13, s15
    s_lshl_b32 s15, s12, 10
    s_lshl_b32 s38, s12, 13
    s_add_u32 s38, s38, 98304
    v_lshrrev_b32 v114, 4, v109
    v_and_b32 v115, 15, v109
    v_add_u32 v116, 0, v114
    v_xor_b32 v104, v115, v116
    v_lshlrev_b32 v104, 4, v104
    v_add_u32 v116, s13, v116
    v_lshl_add_u32 v104, v116, 10, v104
    v_add_u32 v116, 4, v114
    v_xor_b32 v105, v115, v116
    v_lshlrev_b32 v105, 4, v105
    v_add_u32 v116, s13, v116
    v_lshl_add_u32 v105, v116, 10, v105
    v_add_u32 v116, 8, v114
    v_xor_b32 v106, v115, v116
    v_lshlrev_b32 v106, 4, v106
    v_add_u32 v116, s13, v116
    v_lshl_add_u32 v106, v116, 10, v106
    v_add_u32 v116, 12, v114
    v_xor_b32 v107, v115, v116
    v_lshlrev_b32 v107, 4, v107
    v_add_u32 v116, s13, v116
    v_lshl_add_u32 v107, v116, 10, v107
    v_add_u32 v114, 0, v108
    v_mul_u32_u24 v115, 43691, v114
    v_lshrrev_b32 v115, 19, v115
    v_mul_u32_u24 v115, 2880, v115
    s_add_u32 m0, s15, 0
    v_lshl_add_u32 v115, v114, 4, v115
    buffer_load_dwordx4 v115, s[20:23], s14 offen lds
    v_add_u32 v114, 256, v108
    v_mul_u32_u24 v115, 43691, v114
    v_lshrrev_b32 v115, 19, v115
    v_mul_u32_u24 v115, 2880, v115
    s_add_u32 m0, s15, 4096
    v_lshl_add_u32 v115, v114, 4, v115
    buffer_load_dwordx4 v115, s[20:23], s14 offen lds
    v_add_u32 v114, 512, v108
    v_mul_u32_u24 v115, 43691, v114
    v_lshrrev_b32 v115, 19, v115
    v_mul_u32_u24 v115, 2880, v115
    s_add_u32 m0, s15, 8192
    v_lshl_add_u32 v115, v114, 4, v115
    buffer_load_dwordx4 v115, s[20:23], s14 offen lds
    v_add_u32 v114, 768, v108
    v_mul_u32_u24 v115, 43691, v114
    v_lshrrev_b32 v115, 19, v115
    v_mul_u32_u24 v115, 2880, v115
    s_add_u32 m0, s15, 12288
    v_lshl_add_u32 v115, v114, 4, v115
    buffer_load_dwordx4 v115, s[20:23], s14 offen lds
    v_add_u32 v114, 1024, v108
    v_mul_u32_u24 v115, 43691, v114
    v_lshrrev_b32 v115, 19, v115
    v_mul_u32_u24 v115, 2880, v115
    s_add_u32 m0, s15, 16384
    v_lshl_add_u32 v115, v114, 4, v115
    buffer_load_dwordx4 v115, s[20:23], s14 offen lds
    v_add_u32 v114, 1280, v108
    v_mul_u32_u24 v115, 43691, v114
    v_lshrrev_b32 v115, 19, v115
    v_mul_u32_u24 v115, 2880, v115
    s_add_u32 m0, s15, 20480
    v_lshl_add_u32 v115, v114, 4, v115
    buffer_load_dwordx4 v115, s[20:23], s14 offen lds
    s_add_u32 m0, s38, 0
    s_mov_b32 s39, 0
    buffer_load_dwordx4 v104, s[16:19], s39 offen lds
    s_add_u32 m0, s38, 1024
    s_mov_b32 s39, 0
    buffer_load_dwordx4 v105, s[16:19], s39 offen lds
    s_add_u32 m0, s38, 2048
    s_mov_b32 s39, 0
    buffer_load_dwordx4 v106, s[16:19], s39 offen lds
    s_add_u32 m0, s38, 3072
    s_mov_b32 s39, 0
    buffer_load_dwordx4 v107, s[16:19], s39 offen lds
    s_add_u32 m0, s38, 4096
    s_mov_b32 s39, 16384
    buffer_load_dwordx4 v104, s[16:19], s39 offen lds
    s_add_u32 m0, s38, 5120
    s_mov_b32 s39, 16384
    buffer_load_dwordx4 v105, s[16:19], s39 offen lds
    s_add_u32 m0, s38, 6144
    s_mov_b32 s39, 16384
    buffer_load_dwordx4 v106, s[16:19], s39 offen lds
    s_add_u32 m0, s38, 7168
    s_mov_b32 s39, 16384
    buffer_load_dwordx4 v107, s[16:19], s39 offen lds
    v_add_u32 v114, 1536, v108
    v_mul_u32_u24 v115, 43691, v114
    v_lshrrev_b32 v115, 19, v115
    v_mul_u32_u24 v115, 2880, v115
    s_add_u32 m0, s15, 24576
    v_lshl_add_u32 v115, v114, 4, v115
    buffer_load_dwordx4 v115, s[20:23], s14 offen lds
    v_add_u32 v114, 1792, v108
    v_mul_u32_u24 v115, 43691, v114
    v_lshrrev_b32 v115, 19, v115
    v_mul_u32_u24 v115, 2880, v115
    s_add_u32 m0, s15, 28672
    v_lshl_add_u32 v115, v114, 4, v115
    buffer_load_dwordx4 v115, s[20:23], s14 offen lds
    v_add_u32 v114, 2048, v108
    v_mul_u32_u24 v115, 43691, v114
    v_lshrrev_b32 v115, 19, v115
    v_mul_u32_u24 v115, 2880, v115
    s_add_u32 m0, s15, 32768
    v_lshl_add_u32 v115, v114, 4, v115
    buffer_load_dwordx4 v115, s[20:23], s14 offen lds
    v_add_u32 v114, 2304, v108
    v_mul_u32_u24 v115, 43691, v114
    v_lshrrev_b32 v115, 19, v115
    v_mul_u32_u24 v115, 2880, v115
    s_add_u32 m0, s15, 36864
    v_lshl_add_u32 v115, v114, 4, v115
    buffer_load_dwordx4 v115, s[20:23], s14 offen lds
    v_add_u32 v114, 2560, v108
    v_mul_u32_u24 v115, 43691, v114
    v_lshrrev_b32 v115, 19, v115
    v_mul_u32_u24 v115, 2880, v115
    s_add_u32 m0, s15, 40960
    v_lshl_add_u32 v115, v114, 4, v115
    buffer_load_dwordx4 v115, s[20:23], s14 offen lds
    v_add_u32 v114, 2816, v108
    v_mul_u32_u24 v115, 43691, v114
    v_lshrrev_b32 v115, 19, v115
    v_mul_u32_u24 v115, 2880, v115
    s_add_u32 m0, s15, 45056
    v_lshl_add_u32 v115, v114, 4, v115
    buffer_load_dwordx4 v115, s[20:23], s14 offen lds
    s_add_u32 m0, s38, 32768
    s_mov_b32 s39, 256
    buffer_load_dwordx4 v104, s[16:19], s39 offen lds
    s_add_u32 m0, s38, 33792
    s_mov_b32 s39, 256
    buffer_load_dwordx4 v105, s[16:19], s39 offen lds
    s_add_u32 m0, s38, 34816
    s_mov_b32 s39, 256
    buffer_load_dwordx4 v106, s[16:19], s39 offen lds
    s_add_u32 m0, s38, 35840
    s_mov_b32 s39, 256
    buffer_load_dwordx4 v107, s[16:19], s39 offen lds
    s_add_u32 m0, s38, 36864
    s_mov_b32 s39, 16640
    buffer_load_dwordx4 v104, s[16:19], s39 offen lds
    s_add_u32 m0, s38, 37888
    s_mov_b32 s39, 16640
    buffer_load_dwordx4 v105, s[16:19], s39 offen lds
    s_add_u32 m0, s38, 38912
    s_mov_b32 s39, 16640
    buffer_load_dwordx4 v106, s[16:19], s39 offen lds
    s_add_u32 m0, s38, 39936
    s_mov_b32 s39, 16640
    buffer_load_dwordx4 v107, s[16:19], s39 offen lds
    v_add_u32 v114, 3072, v108
    v_mul_u32_u24 v115, 43691, v114
    v_lshrrev_b32 v115, 19, v115
    v_mul_u32_u24 v115, 2880, v115
    s_add_u32 m0, s15, 49152
    v_lshl_add_u32 v115, v114, 4, v115
    buffer_load_dwordx4 v115, s[20:23], s14 offen lds
    v_add_u32 v114, 3328, v108
    v_mul_u32_u24 v115, 43691, v114
    v_lshrrev_b32 v115, 19, v115
    v_mul_u32_u24 v115, 2880, v115
    s_add_u32 m0, s15, 53248
    v_lshl_add_u32 v115, v114, 4, v115
    buffer_load_dwordx4 v115, s[20:23], s14 offen lds
    v_add_u32 v114, 3584, v108
    v_mul_u32_u24 v115, 43691, v114
    v_lshrrev_b32 v115, 19, v115
    v_mul_u32_u24 v115, 2880, v115
    s_add_u32 m0, s15, 57344
    v_lshl_add_u32 v115, v114, 4, v115
    buffer_load_dwordx4 v115, s[20:23], s14 offen lds
    v_add_u32 v114, 3840, v108
    v_mul_u32_u24 v115, 43691, v114
    v_lshrrev_b32 v115, 19, v115
    v_mul_u32_u24 v115, 2880, v115
    s_add_u32 m0, s15, 61440
    v_lshl_add_u32 v115, v114, 4, v115
    buffer_load_dwordx4 v115, s[20:23], s14 offen lds
    v_add_u32 v114, 4096, v108
    v_mul_u32_u24 v115, 43691, v114
    v_lshrrev_b32 v115, 19, v115
    v_mul_u32_u24 v115, 2880, v115
    s_add_u32 m0, s15, 65536
    v_lshl_add_u32 v115, v114, 4, v115
    buffer_load_dwordx4 v115, s[20:23], s14 offen lds
    v_add_u32 v114, 4352, v108
    v_mul_u32_u24 v115, 43691, v114
    v_lshrrev_b32 v115, 19, v115
    v_mul_u32_u24 v115, 2880, v115
    s_add_u32 m0, s15, 69632
    v_lshl_add_u32 v115, v114, 4, v115
    buffer_load_dwordx4 v115, s[20:23], s14 offen lds
    v_add_u32 v114, 4608, v108
    v_mul_u32_u24 v115, 43691, v114
    v_lshrrev_b32 v115, 19, v115
    v_mul_u32_u24 v115, 2880, v115
    s_add_u32 m0, s15, 73728
    v_lshl_add_u32 v115, v114, 4, v115
    buffer_load_dwordx4 v115, s[20:23], s14 offen lds
    v_add_u32 v114, 4864, v108
    v_mul_u32_u24 v115, 43691, v114
    v_lshrrev_b32 v115, 19, v115
    v_mul_u32_u24 v115, 2880, v115
    s_add_u32 m0, s15, 77824
    v_lshl_add_u32 v115, v114, 4, v115
    buffer_load_dwordx4 v115, s[20:23], s14 offen lds
    v_add_u32 v114, 5120, v108
    v_mul_u32_u24 v115, 43691, v114
    v_lshrrev_b32 v115, 19, v115
    v_mul_u32_u24 v115, 2880, v115
    s_add_u32 m0, s15, 81920
    v_lshl_add_u32 v115, v114, 4, v115
    buffer_load_dwordx4 v115, s[20:23], s14 offen lds
    v_add_u32 v114, 5376, v108
    v_mul_u32_u24 v115, 43691, v114
    v_lshrrev_b32 v115, 19, v115
    v_mul_u32_u24 v115, 2880, v115
    s_add_u32 m0, s15, 86016
    v_lshl_add_u32 v115, v114, 4, v115
    buffer_load_dwordx4 v115, s[20:23], s14 offen lds
    v_add_u32 v114, 5632, v108
    v_mul_u32_u24 v115, 43691, v114
    v_lshrrev_b32 v115, 19, v115
    v_mul_u32_u24 v115, 2880, v115
    s_add_u32 m0, s15, 90112
    v_lshl_add_u32 v115, v114, 4, v115
    buffer_load_dwordx4 v115, s[20:23], s14 offen lds
    v_add_u32 v114, 5888, v108
    v_mul_u32_u24 v115, 43691, v114
    v_lshrrev_b32 v115, 19, v115
    v_mul_u32_u24 v115, 2880, v115
    s_add_u32 m0, s15, 94208
    v_lshl_add_u32 v115, v114, 4, v115
    buffer_load_dwordx4 v115, s[20:23], s14 offen lds
    v_and_b32 v114, 31, v109
    v_lshrrev_b32 v110, 5, v109
    v_add_u32 v111, s13, v114
    v_and_b32 v115, 15, v114
    v_lshlrev_b32 v116, 1, v110
    v_xor_b32 v115, v115, v116
    v_lshlrev_b32 v114, 8, v114
    v_add_u32 v114, s38, v114
    v_xor_b32 v116, 0, v115
    v_lshl_add_u32 v96, v116, 4, v114
    v_xor_b32 v116, 1, v115
    v_lshl_add_u32 v97, v116, 4, v114
    v_xor_b32 v116, 4, v115
    v_lshl_add_u32 v98, v116, 4, v114
    v_xor_b32 v116, 5, v115
    v_lshl_add_u32 v99, v116, 4, v114
    v_xor_b32 v116, 8, v115
    v_lshl_add_u32 v100, v116, 4, v114
    v_xor_b32 v116, 9, v115
    v_lshl_add_u32 v101, v116, 4, v114
    v_xor_b32 v116, 12, v115
    v_lshl_add_u32 v102, v116, 4, v114
    v_xor_b32 v116, 13, v115
    v_lshl_add_u32 v103, v116, 4, v114
    v_bfe_u32 v114, v109, 2, 2
    v_lshl_add_u32 v112, v110, 4, v114
    v_mul_u32_u24 v112, 192, v112
    v_bfe_u32 v114, v109, 4, 1
    v_lshl_add_u32 v112, v114, 5, v112
    v_and_b32 v114, 3, v109
    v_lshl_add_u32 v112, v114, 3, v112
    v_add_u32 v113, 49152, v112
    v_mov_b32 v0, 0
    v_mov_b32 v1, 0
    v_mov_b32 v2, 0
    v_mov_b32 v3, 0
    v_mov_b32 v4, 0
    v_mov_b32 v5, 0
    v_mov_b32 v6, 0
    v_mov_b32 v7, 0
    v_mov_b32 v8, 0
    v_mov_b32 v9, 0
    v_mov_b32 v10, 0
    v_mov_b32 v11, 0
    v_mov_b32 v12, 0
    v_mov_b32 v13, 0
    v_mov_b32 v14, 0
    v_mov_b32 v15, 0
    v_mov_b32 v16, 0
    v_mov_b32 v17, 0
    v_mov_b32 v18, 0
    v_mov_b32 v19, 0
    v_mov_b32 v20, 0
    v_mov_b32 v21, 0
    v_mov_b32 v22, 0
    v_mov_b32 v23, 0
    v_mov_b32 v24, 0
    v_mov_b32 v25, 0
    v_mov_b32 v26, 0
    v_mov_b32 v27, 0
    v_mov_b32 v28, 0
    v_mov_b32 v29, 0
    v_mov_b32 v30, 0
    v_mov_b32 v31, 0
    v_mov_b32 v32, 0
    v_mov_b32 v33, 0
    v_mov_b32 v34, 0
    v_mov_b32 v35, 0
    v_mov_b32 v36, 0
    v_mov_b32 v37, 0
    v_mov_b32 v38, 0
    v_mov_b32 v39, 0
    v_mov_b32 v40, 0
    v_mov_b32 v41, 0
    v_mov_b32 v42, 0
    v_mov_b32 v43, 0
    v_mov_b32 v44, 0
    v_mov_b32 v45, 0
    v_mov_b32 v46, 0
    v_mov_b32 v47, 0
    s_waitcnt vmcnt(26)
    s_barrier
    ds_read_b128 v[84:87], v96 offset:0
    ds_read_b64_tr_b16 v[48:49], v112 offset:0
    ds_read_b64_tr_b16 v[50:51], v112 offset:768
    ds_read_b64_tr_b16 v[52:53], v112 offset:64
    ds_read_b64_tr_b16 v[54:55], v112 offset:832
    ds_read_b64_tr_b16 v[56:57], v112 offset:128
    ds_read_b64_tr_b16 v[58:59], v112 offset:896
    ds_read_b128 v[88:91], v97 offset:0
    ds_read_b64_tr_b16 v[60:61], v112 offset:1536
    ds_read_b64_tr_b16 v[62:63], v112 offset:2304
    ds_read_b64_tr_b16 v[64:65], v112 offset:1600
    ds_read_b64_tr_b16 v[66:67], v112 offset:2368
    ds_read_b64_tr_b16 v[68:69], v112 offset:1664
    ds_read_b64_tr_b16 v[70:71], v112 offset:2432
    s_waitcnt lgkmcnt(7)
    ds_read_b128 v[92:95], v98 offset:0
    ds_read_b64_tr_b16 v[72:73], v112 offset:6144
    ds_read_b64_tr_b16 v[74:75], v112 offset:6912
    ds_read_b64_tr_b16 v[76:77], v112 offset:6208
    ds_read_b64_tr_b16 v[78:79], v112 offset:6976
    ds_read_b64_tr_b16 v[80:81], v112 offset:6272
    ds_read_b64_tr_b16 v[82:83], v112 offset:7040
    v_mfma_f32_32x32x16_bf16 v[0:15], v[48:51], v[84:87], v[0:15]
    v_mfma_f32_32x32x16_bf16 v[16:31], v[52:55], v[84:87], v[16:31]
    v_mfma_f32_32x32x16_bf16 v[32:47], v[56:59], v[84:87], v[32:47]
    s_waitcnt lgkmcnt(7)
    ds_read_b128 v[84:87], v99 offset:0
    ds_read_b64_tr_b16 v[48:49], v112 offset:7680
    ds_read_b64_tr_b16 v[50:51], v112 offset:8448
    ds_read_b64_tr_b16 v[52:53], v112 offset:7744
    ds_read_b64_tr_b16 v[54:55], v112 offset:8512
    ds_read_b64_tr_b16 v[56:57], v112 offset:7808
    ds_read_b64_tr_b16 v[58:59], v112 offset:8576
    v_mfma_f32_32x32x16_bf16 v[0:15], v[60:63], v[88:91], v[0:15]
    v_mfma_f32_32x32x16_bf16 v[16:31], v[64:67], v[88:91], v[16:31]
    v_mfma_f32_32x32x16_bf16 v[32:47], v[68:71], v[88:91], v[32:47]
    s_waitcnt lgkmcnt(7)
    ds_read_b128 v[88:91], v100 offset:0
    ds_read_b64_tr_b16 v[60:61], v112 offset:12288
    ds_read_b64_tr_b16 v[62:63], v112 offset:13056
    ds_read_b64_tr_b16 v[64:65], v112 offset:12352
    ds_read_b64_tr_b16 v[66:67], v112 offset:13120
    ds_read_b64_tr_b16 v[68:69], v112 offset:12416
    ds_read_b64_tr_b16 v[70:71], v112 offset:13184
    v_mfma_f32_32x32x16_bf16 v[0:15], v[72:75], v[92:95], v[0:15]
    v_mfma_f32_32x32x16_bf16 v[16:31], v[76:79], v[92:95], v[16:31]
    v_mfma_f32_32x32x16_bf16 v[32:47], v[80:83], v[92:95], v[32:47]
    s_waitcnt lgkmcnt(7)
    ds_read_b128 v[92:95], v101 offset:0
    ds_read_b64_tr_b16 v[72:73], v112 offset:13824
    ds_read_b64_tr_b16 v[74:75], v112 offset:14592
    ds_read_b64_tr_b16 v[76:77], v112 offset:13888
    ds_read_b64_tr_b16 v[78:79], v112 offset:14656
    ds_read_b64_tr_b16 v[80:81], v112 offset:13952
    ds_read_b64_tr_b16 v[82:83], v112 offset:14720
    v_mfma_f32_32x32x16_bf16 v[0:15], v[48:51], v[84:87], v[0:15]
    v_mfma_f32_32x32x16_bf16 v[16:31], v[52:55], v[84:87], v[16:31]
    v_mfma_f32_32x32x16_bf16 v[32:47], v[56:59], v[84:87], v[32:47]
    s_waitcnt lgkmcnt(7)
    ds_read_b128 v[84:87], v102 offset:0
    ds_read_b64_tr_b16 v[48:49], v112 offset:18432
    ds_read_b64_tr_b16 v[50:51], v112 offset:19200
    ds_read_b64_tr_b16 v[52:53], v112 offset:18496
    ds_read_b64_tr_b16 v[54:55], v112 offset:19264
    ds_read_b64_tr_b16 v[56:57], v112 offset:18560
    ds_read_b64_tr_b16 v[58:59], v112 offset:19328
    v_mfma_f32_32x32x16_bf16 v[0:15], v[60:63], v[88:91], v[0:15]
    v_mfma_f32_32x32x16_bf16 v[16:31], v[64:67], v[88:91], v[16:31]
    v_mfma_f32_32x32x16_bf16 v[32:47], v[68:71], v[88:91], v[32:47]
    s_waitcnt lgkmcnt(7)
    ds_read_b128 v[88:91], v103 offset:0
    ds_read_b64_tr_b16 v[60:61], v112 offset:19968
    ds_read_b64_tr_b16 v[62:63], v112 offset:20736
    ds_read_b64_tr_b16 v[64:65], v112 offset:20032
    ds_read_b64_tr_b16 v[66:67], v112 offset:20800
    ds_read_b64_tr_b16 v[68:69], v112 offset:20096
    ds_read_b64_tr_b16 v[70:71], v112 offset:20864
    v_mfma_f32_32x32x16_bf16 v[0:15], v[72:75], v[92:95], v[0:15]
    v_mfma_f32_32x32x16_bf16 v[16:31], v[76:79], v[92:95], v[16:31]
    v_mfma_f32_32x32x16_bf16 v[32:47], v[80:83], v[92:95], v[32:47]
    s_waitcnt lgkmcnt(7)
    v_mfma_f32_32x32x16_bf16 v[0:15], v[48:51], v[84:87], v[0:15]
    v_mfma_f32_32x32x16_bf16 v[16:31], v[52:55], v[84:87], v[16:31]
    v_mfma_f32_32x32x16_bf16 v[32:47], v[56:59], v[84:87], v[32:47]
    s_waitcnt lgkmcnt(0)
    s_add_u32 m0, s38, 0
    s_mov_b32 s39, 512
    buffer_load_dwordx4 v104, s[16:19], s39 offen lds
    s_add_u32 m0, s38, 1024
    s_mov_b32 s39, 512
    buffer_load_dwordx4 v105, s[16:19], s39 offen lds
    s_add_u32 m0, s38, 2048
    s_mov_b32 s39, 512
    buffer_load_dwordx4 v106, s[16:19], s39 offen lds
    s_add_u32 m0, s38, 3072
    s_mov_b32 s39, 512
    buffer_load_dwordx4 v107, s[16:19], s39 offen lds
    s_add_u32 m0, s38, 4096
    s_mov_b32 s39, 16896
    buffer_load_dwordx4 v104, s[16:19], s39 offen lds
    s_add_u32 m0, s38, 5120
    s_mov_b32 s39, 16896
    buffer_load_dwordx4 v105, s[16:19], s39 offen lds
    s_add_u32 m0, s38, 6144
    s_mov_b32 s39, 16896
    buffer_load_dwordx4 v106, s[16:19], s39 offen lds
    s_add_u32 m0, s38, 7168
    s_mov_b32 s39, 16896
    buffer_load_dwordx4 v107, s[16:19], s39 offen lds
    v_mfma_f32_32x32x16_bf16 v[0:15], v[60:63], v[88:91], v[0:15]
    v_mfma_f32_32x32x16_bf16 v[16:31], v[64:67], v[88:91], v[16:31]
    v_mfma_f32_32x32x16_bf16 v[32:47], v[68:71], v[88:91], v[32:47]
    s_waitcnt vmcnt(20)
    s_barrier
    ds_read_b128 v[92:95], v96 offset:32768
    ds_read_b64_tr_b16 v[72:73], v112 offset:24576
    ds_read_b64_tr_b16 v[74:75], v112 offset:25344
    ds_read_b64_tr_b16 v[76:77], v112 offset:24640
    ds_read_b64_tr_b16 v[78:79], v112 offset:25408
    ds_read_b64_tr_b16 v[80:81], v112 offset:24704
    ds_read_b64_tr_b16 v[82:83], v112 offset:25472
    ds_read_b128 v[84:87], v97 offset:32768
    ds_read_b64_tr_b16 v[48:49], v112 offset:26112
    ds_read_b64_tr_b16 v[50:51], v112 offset:26880
    ds_read_b64_tr_b16 v[52:53], v112 offset:26176
    ds_read_b64_tr_b16 v[54:55], v112 offset:26944
    ds_read_b64_tr_b16 v[56:57], v112 offset:26240
    ds_read_b64_tr_b16 v[58:59], v112 offset:27008
    s_waitcnt lgkmcnt(7)
    ds_read_b128 v[88:91], v98 offset:32768
    ds_read_b64_tr_b16 v[60:61], v112 offset:30720
    ds_read_b64_tr_b16 v[62:63], v112 offset:31488
    ds_read_b64_tr_b16 v[64:65], v112 offset:30784
    ds_read_b64_tr_b16 v[66:67], v112 offset:31552
    ds_read_b64_tr_b16 v[68:69], v112 offset:30848
    ds_read_b64_tr_b16 v[70:71], v112 offset:31616
    v_mfma_f32_32x32x16_bf16 v[0:15], v[72:75], v[92:95], v[0:15]
    v_mfma_f32_32x32x16_bf16 v[16:31], v[76:79], v[92:95], v[16:31]
    v_mfma_f32_32x32x16_bf16 v[32:47], v[80:83], v[92:95], v[32:47]
    s_waitcnt lgkmcnt(7)
    ds_read_b128 v[92:95], v99 offset:32768
    ds_read_b64_tr_b16 v[72:73], v112 offset:32256
    ds_read_b64_tr_b16 v[74:75], v112 offset:33024
    ds_read_b64_tr_b16 v[76:77], v112 offset:32320
    ds_read_b64_tr_b16 v[78:79], v112 offset:33088
    ds_read_b64_tr_b16 v[80:81], v112 offset:32384
    ds_read_b64_tr_b16 v[82:83], v112 offset:33152
    v_mfma_f32_32x32x16_bf16 v[0:15], v[48:51], v[84:87], v[0:15]
    v_mfma_f32_32x32x16_bf16 v[16:31], v[52:55], v[84:87], v[16:31]
    v_mfma_f32_32x32x16_bf16 v[32:47], v[56:59], v[84:87], v[32:47]
    s_waitcnt lgkmcnt(7)
    ds_read_b128 v[84:87], v100 offset:32768
    ds_read_b64_tr_b16 v[48:49], v112 offset:36864
    ds_read_b64_tr_b16 v[50:51], v112 offset:37632
    ds_read_b64_tr_b16 v[52:53], v112 offset:36928
    ds_read_b64_tr_b16 v[54:55], v112 offset:37696
    ds_read_b64_tr_b16 v[56:57], v112 offset:36992
    ds_read_b64_tr_b16 v[58:59], v112 offset:37760
    v_mfma_f32_32x32x16_bf16 v[0:15], v[60:63], v[88:91], v[0:15]
    v_mfma_f32_32x32x16_bf16 v[16:31], v[64:67], v[88:91], v[16:31]
    v_mfma_f32_32x32x16_bf16 v[32:47], v[68:71], v[88:91], v[32:47]
    s_waitcnt lgkmcnt(7)
    ds_read_b128 v[88:91], v101 offset:32768
    ds_read_b64_tr_b16 v[60:61], v112 offset:38400
    ds_read_b64_tr_b16 v[62:63], v112 offset:39168
    ds_read_b64_tr_b16 v[64:65], v112 offset:38464
    ds_read_b64_tr_b16 v[66:67], v112 offset:39232
    ds_read_b64_tr_b16 v[68:69], v112 offset:38528
    ds_read_b64_tr_b16 v[70:71], v112 offset:39296
    v_mfma_f32_32x32x16_bf16 v[0:15], v[72:75], v[92:95], v[0:15]
    v_mfma_f32_32x32x16_bf16 v[16:31], v[76:79], v[92:95], v[16:31]
    v_mfma_f32_32x32x16_bf16 v[32:47], v[80:83], v[92:95], v[32:47]
    s_waitcnt lgkmcnt(7)
    ds_read_b128 v[92:95], v102 offset:32768
    ds_read_b64_tr_b16 v[72:73], v112 offset:43008
    ds_read_b64_tr_b16 v[74:75], v112 offset:43776
    ds_read_b64_tr_b16 v[76:77], v112 offset:43072
    ds_read_b64_tr_b16 v[78:79], v112 offset:43840
    ds_read_b64_tr_b16 v[80:81], v112 offset:43136
    ds_read_b64_tr_b16 v[82:83], v112 offset:43904
    v_mfma_f32_32x32x16_bf16 v[0:15], v[48:51], v[84:87], v[0:15]
    v_mfma_f32_32x32x16_bf16 v[16:31], v[52:55], v[84:87], v[16:31]
    v_mfma_f32_32x32x16_bf16 v[32:47], v[56:59], v[84:87], v[32:47]
    s_waitcnt lgkmcnt(7)
    ds_read_b128 v[84:87], v103 offset:32768
    ds_read_b64_tr_b16 v[48:49], v112 offset:44544
    ds_read_b64_tr_b16 v[50:51], v112 offset:45312
    ds_read_b64_tr_b16 v[52:53], v112 offset:44608
    ds_read_b64_tr_b16 v[54:55], v112 offset:45376
    ds_read_b64_tr_b16 v[56:57], v112 offset:44672
    ds_read_b64_tr_b16 v[58:59], v112 offset:45440
    v_mfma_f32_32x32x16_bf16 v[0:15], v[60:63], v[88:91], v[0:15]
    v_mfma_f32_32x32x16_bf16 v[16:31], v[64:67], v[88:91], v[16:31]
    v_mfma_f32_32x32x16_bf16 v[32:47], v[68:71], v[88:91], v[32:47]
    s_waitcnt lgkmcnt(7)
    v_mfma_f32_32x32x16_bf16 v[0:15], v[72:75], v[92:95], v[0:15]
    v_mfma_f32_32x32x16_bf16 v[16:31], v[76:79], v[92:95], v[16:31]
    v_mfma_f32_32x32x16_bf16 v[32:47], v[80:83], v[92:95], v[32:47]
    s_waitcnt lgkmcnt(0)
    s_add_u32 m0, s38, 32768
    s_mov_b32 s39, 768
    buffer_load_dwordx4 v104, s[16:19], s39 offen lds
    s_add_u32 m0, s38, 33792
    s_mov_b32 s39, 768
    buffer_load_dwordx4 v105, s[16:19], s39 offen lds
    s_add_u32 m0, s38, 34816
    s_mov_b32 s39, 768
    buffer_load_dwordx4 v106, s[16:19], s39 offen lds
    s_add_u32 m0, s38, 35840
    s_mov_b32 s39, 768
    buffer_load_dwordx4 v107, s[16:19], s39 offen lds
    s_add_u32 m0, s38, 36864
    s_mov_b32 s39, 17152
    buffer_load_dwordx4 v104, s[16:19], s39 offen lds
    s_add_u32 m0, s38, 37888
    s_mov_b32 s39, 17152
    buffer_load_dwordx4 v105, s[16:19], s39 offen lds
    s_add_u32 m0, s38, 38912
    s_mov_b32 s39, 17152
    buffer_load_dwordx4 v106, s[16:19], s39 offen lds
    s_add_u32 m0, s38, 39936
    s_mov_b32 s39, 17152
    buffer_load_dwordx4 v107, s[16:19], s39 offen lds
    v_mfma_f32_32x32x16_bf16 v[0:15], v[48:51], v[84:87], v[0:15]
    v_mfma_f32_32x32x16_bf16 v[16:31], v[52:55], v[84:87], v[16:31]
    v_mfma_f32_32x32x16_bf16 v[32:47], v[56:59], v[84:87], v[32:47]
    s_waitcnt vmcnt(8)
    s_barrier
    ds_read_b128 v[88:91], v96 offset:0
    ds_read_b64_tr_b16 v[60:61], v113 offset:0
    ds_read_b64_tr_b16 v[62:63], v113 offset:768
    ds_read_b64_tr_b16 v[64:65], v113 offset:64
    ds_read_b64_tr_b16 v[66:67], v113 offset:832
    ds_read_b64_tr_b16 v[68:69], v113 offset:128
    ds_read_b64_tr_b16 v[70:71], v113 offset:896
    ds_read_b128 v[92:95], v97 offset:0
    ds_read_b64_tr_b16 v[72:73], v113 offset:1536
    ds_read_b64_tr_b16 v[74:75], v113 offset:2304
    ds_read_b64_tr_b16 v[76:77], v113 offset:1600
    ds_read_b64_tr_b16 v[78:79], v113 offset:2368
    ds_read_b64_tr_b16 v[80:81], v113 offset:1664
    ds_read_b64_tr_b16 v[82:83], v113 offset:2432
    s_waitcnt lgkmcnt(7)
    ds_read_b128 v[84:87], v98 offset:0
    ds_read_b64_tr_b16 v[48:49], v113 offset:6144
    ds_read_b64_tr_b16 v[50:51], v113 offset:6912
    ds_read_b64_tr_b16 v[52:53], v113 offset:6208
    ds_read_b64_tr_b16 v[54:55], v113 offset:6976
    ds_read_b64_tr_b16 v[56:57], v113 offset:6272
    ds_read_b64_tr_b16 v[58:59], v113 offset:7040
    v_mfma_f32_32x32x16_bf16 v[0:15], v[60:63], v[88:91], v[0:15]
    v_mfma_f32_32x32x16_bf16 v[16:31], v[64:67], v[88:91], v[16:31]
    v_mfma_f32_32x32x16_bf16 v[32:47], v[68:71], v[88:91], v[32:47]
    s_waitcnt lgkmcnt(7)
    ds_read_b128 v[88:91], v99 offset:0
    ds_read_b64_tr_b16 v[60:61], v113 offset:7680
    ds_read_b64_tr_b16 v[62:63], v113 offset:8448
    ds_read_b64_tr_b16 v[64:65], v113 offset:7744
    ds_read_b64_tr_b16 v[66:67], v113 offset:8512
    ds_read_b64_tr_b16 v[68:69], v113 offset:7808
    ds_read_b64_tr_b16 v[70:71], v113 offset:8576
    v_mfma_f32_32x32x16_bf16 v[0:15], v[72:75], v[92:95], v[0:15]
    v_mfma_f32_32x32x16_bf16 v[16:31], v[76:79], v[92:95], v[16:31]
    v_mfma_f32_32x32x16_bf16 v[32:47], v[80:83], v[92:95], v[32:47]
    s_waitcnt lgkmcnt(7)
    ds_read_b128 v[92:95], v100 offset:0
    ds_read_b64_tr_b16 v[72:73], v113 offset:12288
    ds_read_b64_tr_b16 v[74:75], v113 offset:13056
    ds_read_b64_tr_b16 v[76:77], v113 offset:12352
    ds_read_b64_tr_b16 v[78:79], v113 offset:13120
    ds_read_b64_tr_b16 v[80:81], v113 offset:12416
    ds_read_b64_tr_b16 v[82:83], v113 offset:13184
    v_mfma_f32_32x32x16_bf16 v[0:15], v[48:51], v[84:87], v[0:15]
    v_mfma_f32_32x32x16_bf16 v[16:31], v[52:55], v[84:87], v[16:31]
    v_mfma_f32_32x32x16_bf16 v[32:47], v[56:59], v[84:87], v[32:47]
    s_waitcnt lgkmcnt(7)
    ds_read_b128 v[84:87], v101 offset:0
    ds_read_b64_tr_b16 v[48:49], v113 offset:13824
    ds_read_b64_tr_b16 v[50:51], v113 offset:14592
    ds_read_b64_tr_b16 v[52:53], v113 offset:13888
    ds_read_b64_tr_b16 v[54:55], v113 offset:14656
    ds_read_b64_tr_b16 v[56:57], v113 offset:13952
    ds_read_b64_tr_b16 v[58:59], v113 offset:14720
    v_mfma_f32_32x32x16_bf16 v[0:15], v[60:63], v[88:91], v[0:15]
    v_mfma_f32_32x32x16_bf16 v[16:31], v[64:67], v[88:91], v[16:31]
    v_mfma_f32_32x32x16_bf16 v[32:47], v[68:71], v[88:91], v[32:47]
    s_waitcnt lgkmcnt(7)
    ds_read_b128 v[88:91], v102 offset:0
    ds_read_b64_tr_b16 v[60:61], v113 offset:18432
    ds_read_b64_tr_b16 v[62:63], v113 offset:19200
    ds_read_b64_tr_b16 v[64:65], v113 offset:18496
    ds_read_b64_tr_b16 v[66:67], v113 offset:19264
    ds_read_b64_tr_b16 v[68:69], v113 offset:18560
    ds_read_b64_tr_b16 v[70:71], v113 offset:19328
    v_mfma_f32_32x32x16_bf16 v[0:15], v[72:75], v[92:95], v[0:15]
    v_mfma_f32_32x32x16_bf16 v[16:31], v[76:79], v[92:95], v[16:31]
    v_mfma_f32_32x32x16_bf16 v[32:47], v[80:83], v[92:95], v[32:47]
    s_waitcnt lgkmcnt(7)
    ds_read_b128 v[92:95], v103 offset:0
    ds_read_b64_tr_b16 v[72:73], v113 offset:19968
    ds_read_b64_tr_b16 v[74:75], v113 offset:20736
    ds_read_b64_tr_b16 v[76:77], v113 offset:20032
    ds_read_b64_tr_b16 v[78:79], v113 offset:20800
    ds_read_b64_tr_b16 v[80:81], v113 offset:20096
    ds_read_b64_tr_b16 v[82:83], v113 offset:20864
    v_mfma_f32_32x32x16_bf16 v[0:15], v[48:51], v[84:87], v[0:15]
    v_mfma_f32_32x32x16_bf16 v[16:31], v[52:55], v[84:87], v[16:31]
    v_mfma_f32_32x32x16_bf16 v[32:47], v[56:59], v[84:87], v[32:47]
    s_waitcnt lgkmcnt(7)
    v_mfma_f32_32x32x16_bf16 v[0:15], v[60:63], v[88:91], v[0:15]
    v_mfma_f32_32x32x16_bf16 v[16:31], v[64:67], v[88:91], v[16:31]
    v_mfma_f32_32x32x16_bf16 v[32:47], v[68:71], v[88:91], v[32:47]
    s_waitcnt lgkmcnt(0)
    v_mfma_f32_32x32x16_bf16 v[0:15], v[72:75], v[92:95], v[0:15]
    v_mfma_f32_32x32x16_bf16 v[16:31], v[76:79], v[92:95], v[16:31]
    v_mfma_f32_32x32x16_bf16 v[32:47], v[80:83], v[92:95], v[32:47]
    s_waitcnt vmcnt(0)
    s_barrier
    ds_read_b128 v[84:87], v96 offset:32768
    ds_read_b64_tr_b16 v[48:49], v113 offset:24576
    ds_read_b64_tr_b16 v[50:51], v113 offset:25344
    ds_read_b64_tr_b16 v[52:53], v113 offset:24640
    ds_read_b64_tr_b16 v[54:55], v113 offset:25408
    ds_read_b64_tr_b16 v[56:57], v113 offset:24704
    ds_read_b64_tr_b16 v[58:59], v113 offset:25472
    ds_read_b128 v[88:91], v97 offset:32768
    ds_read_b64_tr_b16 v[60:61], v113 offset:26112
    ds_read_b64_tr_b16 v[62:63], v113 offset:26880
    ds_read_b64_tr_b16 v[64:65], v113 offset:26176
    ds_read_b64_tr_b16 v[66:67], v113 offset:26944
    ds_read_b64_tr_b16 v[68:69], v113 offset:26240
    ds_read_b64_tr_b16 v[70:71], v113 offset:27008
    s_waitcnt lgkmcnt(7)
    ds_read_b128 v[92:95], v98 offset:32768
    ds_read_b64_tr_b16 v[72:73], v113 offset:30720
    ds_read_b64_tr_b16 v[74:75], v113 offset:31488
    ds_read_b64_tr_b16 v[76:77], v113 offset:30784
    ds_read_b64_tr_b16 v[78:79], v113 offset:31552
    ds_read_b64_tr_b16 v[80:81], v113 offset:30848
    ds_read_b64_tr_b16 v[82:83], v113 offset:31616
    v_mfma_f32_32x32x16_bf16 v[0:15], v[48:51], v[84:87], v[0:15]
    v_mfma_f32_32x32x16_bf16 v[16:31], v[52:55], v[84:87], v[16:31]
    v_mfma_f32_32x32x16_bf16 v[32:47], v[56:59], v[84:87], v[32:47]
    s_waitcnt lgkmcnt(7)
    ds_read_b128 v[84:87], v99 offset:32768
    ds_read_b64_tr_b16 v[48:49], v113 offset:32256
    ds_read_b64_tr_b16 v[50:51], v113 offset:33024
    ds_read_b64_tr_b16 v[52:53], v113 offset:32320
    ds_read_b64_tr_b16 v[54:55], v113 offset:33088
    ds_read_b64_tr_b16 v[56:57], v113 offset:32384
    ds_read_b64_tr_b16 v[58:59], v113 offset:33152
    v_mfma_f32_32x32x16_bf16 v[0:15], v[60:63], v[88:91], v[0:15]
    v_mfma_f32_32x32x16_bf16 v[16:31], v[64:67], v[88:91], v[16:31]
    v_mfma_f32_32x32x16_bf16 v[32:47], v[68:71], v[88:91], v[32:47]
    s_waitcnt lgkmcnt(7)
    ds_read_b128 v[88:91], v100 offset:32768
    ds_read_b64_tr_b16 v[60:61], v113 offset:36864
    ds_read_b64_tr_b16 v[62:63], v113 offset:37632
    ds_read_b64_tr_b16 v[64:65], v113 offset:36928
    ds_read_b64_tr_b16 v[66:67], v113 offset:37696
    ds_read_b64_tr_b16 v[68:69], v113 offset:36992
    ds_read_b64_tr_b16 v[70:71], v113 offset:37760
    v_mfma_f32_32x32x16_bf16 v[0:15], v[72:75], v[92:95], v[0:15]
    v_mfma_f32_32x32x16_bf16 v[16:31], v[76:79], v[92:95], v[16:31]
    v_mfma_f32_32x32x16_bf16 v[32:47], v[80:83], v[92:95], v[32:47]
    s_waitcnt lgkmcnt(7)
    ds_read_b128 v[92:95], v101 offset:32768
    ds_read_b64_tr_b16 v[72:73], v113 offset:38400
    ds_read_b64_tr_b16 v[74:75], v113 offset:39168
    ds_read_b64_tr_b16 v[76:77], v113 offset:38464
    ds_read_b64_tr_b16 v[78:79], v113 offset:39232
    ds_read_b64_tr_b16 v[80:81], v113 offset:38528
    ds_read_b64_tr_b16 v[82:83], v113 offset:39296
    v_mfma_f32_32x32x16_bf16 v[0:15], v[48:51], v[84:87], v[0:15]
    v_mfma_f32_32x32x16_bf16 v[16:31], v[52:55], v[84:87], v[16:31]
    v_mfma_f32_32x32x16_bf16 v[32:47], v[56:59], v[84:87], v[32:47]
    s_waitcnt lgkmcnt(7)
    ds_read_b128 v[84:87], v102 offset:32768
    ds_read_b64_tr_b16 v[48:49], v113 offset:43008
    ds_read_b64_tr_b16 v[50:51], v113 offset:43776
    ds_read_b64_tr_b16 v[52:53], v113 offset:43072
    ds_read_b64_tr_b16 v[54:55], v113 offset:43840
    ds_read_b64_tr_b16 v[56:57], v113 offset:43136
    ds_read_b64_tr_b16 v[58:59], v113 offset:43904
    v_mfma_f32_32x32x16_bf16 v[0:15], v[60:63], v[88:91], v[0:15]
    v_mfma_f32_32x32x16_bf16 v[16:31], v[64:67], v[88:91], v[16:31]
    v_mfma_f32_32x32x16_bf16 v[32:47], v[68:71], v[88:91], v[32:47]
    s_waitcnt lgkmcnt(7)
    ds_read_b128 v[88:91], v103 offset:32768
    ds_read_b64_tr_b16 v[60:61], v113 offset:44544
    ds_read_b64_tr_b16 v[62:63], v113 offset:45312
    ds_read_b64_tr_b16 v[64:65], v113 offset:44608
    ds_read_b64_tr_b16 v[66:67], v113 offset:45376
    ds_read_b64_tr_b16 v[68:69], v113 offset:44672
    ds_read_b64_tr_b16 v[70:71], v113 offset:45440
    v_mfma_f32_32x32x16_bf16 v[0:15], v[72:75], v[92:95], v[0:15]
    v_mfma_f32_32x32x16_bf16 v[16:31], v[76:79], v[92:95], v[16:31]
    v_mfma_f32_32x32x16_bf16 v[32:47], v[80:83], v[92:95], v[32:47]
    s_waitcnt lgkmcnt(7)
    v_mfma_f32_32x32x16_bf16 v[0:15], v[48:51], v[84:87], v[0:15]
    v_mfma_f32_32x32x16_bf16 v[16:31], v[52:55], v[84:87], v[16:31]
    v_mfma_f32_32x32x16_bf16 v[32:47], v[56:59], v[84:87], v[32:47]
    s_waitcnt lgkmcnt(0)
    v_mfma_f32_32x32x16_bf16 v[0:15], v[60:63], v[88:91], v[0:15]
    v_mfma_f32_32x32x16_bf16 v[16:31], v[64:67], v[88:91], v[16:31]
    v_mfma_f32_32x32x16_bf16 v[32:47], v[68:71], v[88:91], v[32:47]
    s_nop 15
    v_lshlrev_b32 v114, 15, v110
    v_lshl_add_u32 v114, v111, 4, v114
    v_mov_b32 v115, 0
    s_mul_i32 s28, s11, 3
    s_lshr_b32 s35, s13, 3
    s_add_u32 s29, s28, 0
    s_lshr_b32 s30, s29, 4
    s_and_b32 s31, s29, 15
    s_mov_b32 s32, 0x3eb8aa3b
    s_cmp_eq_u32 s30, 0
    s_cselect_b32 s32, s32, 1.0
    v_mul_f32 v0, s32, v0
    v_mul_f32 v1, s32, v1
    v_mul_f32 v2, s32, v2
    v_mul_f32 v3, s32, v3
    v_mul_f32 v4, s32, v4
    v_mul_f32 v5, s32, v5
    v_mul_f32 v6, s32, v6
    v_mul_f32 v7, s32, v7
    v_mul_f32 v8, s32, v8
    v_mul_f32 v9, s32, v9
    v_mul_f32 v10, s32, v10
    v_mul_f32 v11, s32, v11
    v_mul_f32 v12, s32, v12
    v_mul_f32 v13, s32, v13
    v_mul_f32 v14, s32, v14
    v_mul_f32 v15, s32, v15
    s_cmp_lg_u32 s30, 1
    s_cbranch_scc1 L_qkv_nok_2
    s_lshl_b32 s33, s31, 9
    s_add_u32 s33, s33, s35
    s_add_u32 s33, s33, 8388608
    v_mul_f32 v48, v0, v0
    v_fmac_f32 v48, v1, v1
    v_fmac_f32 v48, v2, v2
    v_fmac_f32 v48, v3, v3
    v_fmac_f32 v48, v4, v4
    v_fmac_f32 v48, v5, v5
    v_fmac_f32 v48, v6, v6
    v_fmac_f32 v48, v7, v7
    v_mov_b32 v49, v48
    s_nop 1
    v_permlane32_swap_b32 v48, v49
    s_nop 1
    v_add_f32 v48, v48, v49
    s_nop 1
    v_max_f32_dpp v48, v48, v48 row_shr:1 row_mask:0xf bank_mask:0xf
    s_nop 1
    v_max_f32_dpp v48, v48, v48 row_shr:2 row_mask:0xf bank_mask:0xf
    s_nop 1
    v_max_f32_dpp v48, v48, v48 row_shr:4 row_mask:0xf bank_mask:0xf
    s_nop 1
    v_max_f32_dpp v48, v48, v48 row_shr:8 row_mask:0xf bank_mask:0xf
    s_nop 1
    v_max_f32_dpp v48, v48, v48 row_bcast:15 row_mask:0xa bank_mask:0xf
    s_nop 1
    v_max_f32_dpp v48, v48, v48 row_bcast:31 row_mask:0xc bank_mask:0xf
    s_nop 1
    v_mul_f32 v50, v8, v8
    v_fmac_f32 v50, v9, v9
    v_fmac_f32 v50, v10, v10
    v_fmac_f32 v50, v11, v11
    v_fmac_f32 v50, v12, v12
    v_fmac_f32 v50, v13, v13
    v_fmac_f32 v50, v14, v14
    v_fmac_f32 v50, v15, v15
    v_mov_b32 v51, v50
    s_nop 1
    v_permlane32_swap_b32 v50, v51
    s_nop 1
    v_add_f32 v50, v50, v51
    s_nop 1
    v_max_f32_dpp v50, v50, v50 row_shr:1 row_mask:0xf bank_mask:0xf
    s_nop 1
    v_max_f32_dpp v50, v50, v50 row_shr:2 row_mask:0xf bank_mask:0xf
    s_nop 1
    v_max_f32_dpp v50, v50, v50 row_shr:4 row_mask:0xf bank_mask:0xf
    s_nop 1
    v_max_f32_dpp v50, v50, v50 row_shr:8 row_mask:0xf bank_mask:0xf
    s_nop 1
    v_max_f32_dpp v50, v50, v50 row_bcast:15 row_mask:0xa bank_mask:0xf
    s_nop 1
    v_max_f32_dpp v50, v50, v50 row_bcast:31 row_mask:0xc bank_mask:0xf
    s_nop 1
    s_mov_b32 s36, 0
    s_mov_b32 s37, 0x80000000
    s_mov_b64 exec, s[36:37]
    buffer_store_dword v48, v115, s[24:27], s33 offen offset:0
    buffer_store_dword v50, v115, s[24:27], s33 offen offset:256
    s_mov_b64 exec, -1
L_qkv_nok_2:
    s_lshl_b32 s33, s30, 21
    s_lshl_b32 s34, s31, 17
    s_add_u32 s33, s33, s34
    v_cvt_pk_bf16_f32 v52, v0, v1
    v_cvt_pk_bf16_f32 v53, v2, v3
    v_cvt_pk_bf16_f32 v54, v4, v5
    v_cvt_pk_bf16_f32 v55, v6, v7
    buffer_store_dwordx4 v[52:55], v114, s[24:27], s33 offen nt
    s_add_u32 s33, s33, 65536
    v_cvt_pk_bf16_f32 v56, v8, v9
    v_cvt_pk_bf16_f32 v57, v10, v11
    v_cvt_pk_bf16_f32 v58, v12, v13
    v_cvt_pk_bf16_f32 v59, v14, v15
    buffer_store_dwordx4 v[56:59], v114, s[24:27], s33 offen nt
    s_add_u32 s33, s33, 65536
    s_add_u32 s29, s28, 1
    s_lshr_b32 s30, s29, 4
    s_and_b32 s31, s29, 15
    s_mov_b32 s32, 0x3eb8aa3b
    s_cmp_eq_u32 s30, 0
    s_cselect_b32 s32, s32, 1.0
    v_mul_f32 v16, s32, v16
    v_mul_f32 v17, s32, v17
    v_mul_f32 v18, s32, v18
    v_mul_f32 v19, s32, v19
    v_mul_f32 v20, s32, v20
    v_mul_f32 v21, s32, v21
    v_mul_f32 v22, s32, v22
    v_mul_f32 v23, s32, v23
    v_mul_f32 v24, s32, v24
    v_mul_f32 v25, s32, v25
    v_mul_f32 v26, s32, v26
    v_mul_f32 v27, s32, v27
    v_mul_f32 v28, s32, v28
    v_mul_f32 v29, s32, v29
    v_mul_f32 v30, s32, v30
    v_mul_f32 v31, s32, v31
    s_cmp_lg_u32 s30, 1
    s_cbranch_scc1 L_qkv_nok_3
    s_lshl_b32 s33, s31, 9
    s_add_u32 s33, s33, s35
    s_add_u32 s33, s33, 8388608
    v_mul_f32 v48, v16, v16
    v_fmac_f32 v48, v17, v17
    v_fmac_f32 v48, v18, v18
    v_fmac_f32 v48, v19, v19
    v_fmac_f32 v48, v20, v20
    v_fmac_f32 v48, v21, v21
    v_fmac_f32 v48, v22, v22
    v_fmac_f32 v48, v23, v23
    v_mov_b32 v49, v48
    s_nop 1
    v_permlane32_swap_b32 v48, v49
    s_nop 1
    v_add_f32 v48, v48, v49
    s_nop 1
    v_max_f32_dpp v48, v48, v48 row_shr:1 row_mask:0xf bank_mask:0xf
    s_nop 1
    v_max_f32_dpp v48, v48, v48 row_shr:2 row_mask:0xf bank_mask:0xf
    s_nop 1
    v_max_f32_dpp v48, v48, v48 row_shr:4 row_mask:0xf bank_mask:0xf
    s_nop 1
    v_max_f32_dpp v48, v48, v48 row_shr:8 row_mask:0xf bank_mask:0xf
    s_nop 1
    v_max_f32_dpp v48, v48, v48 row_bcast:15 row_mask:0xa bank_mask:0xf
    s_nop 1
    v_max_f32_dpp v48, v48, v48 row_bcast:31 row_mask:0xc bank_mask:0xf
    s_nop 1
    v_mul_f32 v50, v24, v24
    v_fmac_f32 v50, v25, v25
    v_fmac_f32 v50, v26, v26
    v_fmac_f32 v50, v27, v27
    v_fmac_f32 v50, v28, v28
    v_fmac_f32 v50, v29, v29
    v_fmac_f32 v50, v30, v30
    v_fmac_f32 v50, v31, v31
    v_mov_b32 v51, v50
    s_nop 1
    v_permlane32_swap_b32 v50, v51
    s_nop 1
    v_add_f32 v50, v50, v51
    s_nop 1
    v_max_f32_dpp v50, v50, v50 row_shr:1 row_mask:0xf bank_mask:0xf
    s_nop 1
    v_max_f32_dpp v50, v50, v50 row_shr:2 row_mask:0xf bank_mask:0xf
    s_nop 1
    v_max_f32_dpp v50, v50, v50 row_shr:4 row_mask:0xf bank_mask:0xf
    s_nop 1
    v_max_f32_dpp v50, v50, v50 row_shr:8 row_mask:0xf bank_mask:0xf
    s_nop 1
    v_max_f32_dpp v50, v50, v50 row_bcast:15 row_mask:0xa bank_mask:0xf
    s_nop 1
    v_max_f32_dpp v50, v50, v50 row_bcast:31 row_mask:0xc bank_mask:0xf
    s_nop 1
    s_mov_b32 s36, 0
    s_mov_b32 s37, 0x80000000
    s_mov_b64 exec, s[36:37]
    buffer_store_dword v48, v115, s[24:27], s33 offen offset:0
    buffer_store_dword v50, v115, s[24:27], s33 offen offset:256
    s_mov_b64 exec, -1
L_qkv_nok_3:
    s_lshl_b32 s33, s30, 21
    s_lshl_b32 s34, s31, 17
    s_add_u32 s33, s33, s34
    v_cvt_pk_bf16_f32 v60, v16, v17
    v_cvt_pk_bf16_f32 v61, v18, v19
    v_cvt_pk_bf16_f32 v62, v20, v21
    v_cvt_pk_bf16_f32 v63, v22, v23
    buffer_store_dwordx4 v[60:63], v114, s[24:27], s33 offen nt
    s_add_u32 s33, s33, 65536
    v_cvt_pk_bf16_f32 v64, v24, v25
    v_cvt_pk_bf16_f32 v65, v26, v27
    v_cvt_pk_bf16_f32 v66, v28, v29
    v_cvt_pk_bf16_f32 v67, v30, v31
    buffer_store_dwordx4 v[64:67], v114, s[24:27], s33 offen nt
    s_add_u32 s33, s33, 65536
    s_add_u32 s29, s28, 2
    s_lshr_b32 s30, s29, 4
    s_and_b32 s31, s29, 15
    s_mov_b32 s32, 0x3eb8aa3b
    s_cmp_eq_u32 s30, 0
    s_cselect_b32 s32, s32, 1.0
    v_mul_f32 v32, s32, v32
    v_mul_f32 v33, s32, v33
    v_mul_f32 v34, s32, v34
    v_mul_f32 v35, s32, v35
    v_mul_f32 v36, s32, v36
    v_mul_f32 v37, s32, v37
    v_mul_f32 v38, s32, v38
    v_mul_f32 v39, s32, v39
    v_mul_f32 v40, s32, v40
    v_mul_f32 v41, s32, v41
    v_mul_f32 v42, s32, v42
    v_mul_f32 v43, s32, v43
    v_mul_f32 v44, s32, v44
    v_mul_f32 v45, s32, v45
    v_mul_f32 v46, s32, v46
    v_mul_f32 v47, s32, v47
    s_cmp_lg_u32 s30, 1
    s_cbranch_scc1 L_qkv_nok_4
    s_lshl_b32 s33, s31, 9
    s_add_u32 s33, s33, s35
    s_add_u32 s33, s33, 8388608
    v_mul_f32 v48, v32, v32
    v_fmac_f32 v48, v33, v33
    v_fmac_f32 v48, v34, v34
    v_fmac_f32 v48, v35, v35
    v_fmac_f32 v48, v36, v36
    v_fmac_f32 v48, v37, v37
    v_fmac_f32 v48, v38, v38
    v_fmac_f32 v48, v39, v39
    v_mov_b32 v49, v48
    s_nop 1
    v_permlane32_swap_b32 v48, v49
    s_nop 1
    v_add_f32 v48, v48, v49
    s_nop 1
    v_max_f32_dpp v48, v48, v48 row_shr:1 row_mask:0xf bank_mask:0xf
    s_nop 1
    v_max_f32_dpp v48, v48, v48 row_shr:2 row_mask:0xf bank_mask:0xf
    s_nop 1
    v_max_f32_dpp v48, v48, v48 row_shr:4 row_mask:0xf bank_mask:0xf
    s_nop 1
    v_max_f32_dpp v48, v48, v48 row_shr:8 row_mask:0xf bank_mask:0xf
    s_nop 1
    v_max_f32_dpp v48, v48, v48 row_bcast:15 row_mask:0xa bank_mask:0xf
    s_nop 1
    v_max_f32_dpp v48, v48, v48 row_bcast:31 row_mask:0xc bank_mask:0xf
    s_nop 1
    v_mul_f32 v50, v40, v40
    v_fmac_f32 v50, v41, v41
    v_fmac_f32 v50, v42, v42
    v_fmac_f32 v50, v43, v43
    v_fmac_f32 v50, v44, v44
    v_fmac_f32 v50, v45, v45
    v_fmac_f32 v50, v46, v46
    v_fmac_f32 v50, v47, v47
    v_mov_b32 v51, v50
    s_nop 1
    v_permlane32_swap_b32 v50, v51
    s_nop 1
    v_add_f32 v50, v50, v51
    s_nop 1
    v_max_f32_dpp v50, v50, v50 row_shr:1 row_mask:0xf bank_mask:0xf
    s_nop 1
    v_max_f32_dpp v50, v50, v50 row_shr:2 row_mask:0xf bank_mask:0xf
    s_nop 1
    v_max_f32_dpp v50, v50, v50 row_shr:4 row_mask:0xf bank_mask:0xf
    s_nop 1
    v_max_f32_dpp v50, v50, v50 row_shr:8 row_mask:0xf bank_mask:0xf
    s_nop 1
    v_max_f32_dpp v50, v50, v50 row_bcast:15 row_mask:0xa bank_mask:0xf
    s_nop 1
    v_max_f32_dpp v50, v50, v50 row_bcast:31 row_mask:0xc bank_mask:0xf
    s_nop 1
    s_mov_b32 s36, 0
    s_mov_b32 s37, 0x80000000
    s_mov_b64 exec, s[36:37]
    buffer_store_dword v48, v115, s[24:27], s33 offen offset:0
    buffer_store_dword v50, v115, s[24:27], s33 offen offset:256
    s_mov_b64 exec, -1
L_qkv_nok_4:
    s_lshl_b32 s33, s30, 21
    s_lshl_b32 s34, s31, 17
    s_add_u32 s33, s33, s34
    v_cvt_pk_bf16_f32 v68, v32, v33
    v_cvt_pk_bf16_f32 v69, v34, v35
    v_cvt_pk_bf16_f32 v70, v36, v37
    v_cvt_pk_bf16_f32 v71, v38, v39
    buffer_store_dwordx4 v[68:71], v114, s[24:27], s33 offen nt
    s_add_u32 s33, s33, 65536
    v_cvt_pk_bf16_f32 v72, v40, v41
    v_cvt_pk_bf16_f32 v73, v42, v43
    v_cvt_pk_bf16_f32 v74, v44, v45
    v_cvt_pk_bf16_f32 v75, v46, v47
    buffer_store_dwordx4 v[72:75], v114, s[24:27], s33 offen nt
    s_add_u32 s33, s33, 65536
L_qkv_end_1:
    s_endpgm
.text
.globl mid_kernel
.p2align 8
.type mid_kernel,@function
mid_kernel:
    s_cmp_ge_u32 s2, 256
    s_cbranch_scc1 L_mid_s4d_5
    s_cmp_ge_u32 s2, 256
    s_cbranch_scc1 L_at_end_6
    s_load_dwordx2 s[8:9], s[0:1], 96
    s_and_b32 s10, s2, 7
    s_lshl_b32 s10, s10, 2
    s_bfe_u32 s11, s2, 0x20003
    s_add_u32 s10, s10, s11
    s_lshr_b32 s11, s2, 5
    v_mov_b32 v100, v0
    v_and_b32 v101, 63, v100
    v_lshrrev_b32 v102, 6, v100
    s_nop 0
    v_readfirstlane_b32 s12, v102
    s_waitcnt lgkmcnt(0)
    s_mov_b32 s24, s8
    s_and_b32 s25, s9, 0xffff
    s_mov_b32 s26, 9437184
    s_mov_b32 s27, 0x00020000
    s_lshl_b32 s13, s10, 16
    v_and_b32 v105, 31, v101
    v_lshrrev_b32 v106, 5, v101
    s_lshl_b32 s15, s11, 8
    s_lshl_b32 s16, s12, 5
    s_add_u32 s15, s15, s16
    v_add_u32 v107, s15, v105
    v_lshlrev_b32 v108, 15, v106
    v_lshl_add_u32 v108, v107, 4, v108
    s_add_u32 s14, s13, 0
    buffer_load_dwordx4 v[64:67], v108, s[24:27], s14 offen
    v_lshlrev_b32 v104, 2, v101
    s_lshl_b32 s14, s10, 8
    s_add_u32 s14, s14, 8388608
    buffer_load_dword v116, v104, s[24:27], s14 offen
    s_and_b32 s28, s12, 1
    s_bfe_u32 s29, s12, 0x10001
    s_lshr_b32 s30, s12, 2
    s_lshl_b32 s30, s30, 12
    s_lshl_b32 s31, s28, 15
    s_mul_i32 s33, s29, 2097152
    s_add_u32 s31, s31, s33
    s_add_u32 s31, s31, s30
    s_add_u32 s31, s31, s13
    s_add_u32 s31, s31, 2097152
    s_and_b32 s33, s12, 3
    s_lshl_b32 s32, s33, 13
    s_add_u32 s32, s32, s30
    s_cmp_eq_u32 s33, 3
    s_cselect_b32 s33, 64, 0
    s_add_u32 s32, s32, s33
    v_lshlrev_b32 v103, 4, v101
    s_add_u32 s34, s31, 0
    s_add_u32 s35, s32, 0
    s_add_u32 m0, s35, 0
    s_add_u32 s36, s34, 0
    buffer_load_dwordx4 v103, s[24:27], s36 offen lds
    s_add_u32 m0, s35, 1024
    s_add_u32 s36, s34, 1024
    buffer_load_dwordx4 v103, s[24:27], s36 offen lds
    s_add_u32 m0, s35, 2048
    s_add_u32 s36, s34, 2048
    buffer_load_dwordx4 v103, s[24:27], s36 offen lds
    s_add_u32 m0, s35, 3072
    s_add_u32 s36, s34, 3072
    buffer_load_dwordx4 v103, s[24:27], s36 offen lds
    s_add_u32 s34, s31, 8192
    s_add_u32 s35, s32, 32896
    s_add_u32 m0, s35, 0
    s_add_u32 s36, s34, 0
    buffer_load_dwordx4 v103, s[24:27], s36 offen lds
    s_add_u32 m0, s35, 1024
    s_add_u32 s36, s34, 1024
    buffer_load_dwordx4 v103, s[24:27], s36 offen lds
    s_add_u32 m0, s35, 2048
    s_add_u32 s36, s34, 2048
    buffer_load_dwordx4 v103, s[24:27], s36 offen lds
    s_add_u32 m0, s35, 3072
    s_add_u32 s36, s34, 3072
    buffer_load_dwordx4 v103, s[24:27], s36 offen lds
    v_lshlrev_b32 v109, 13, v106
    v_lshl_add_u32 v109, v105, 4, v109
    v_and_b32 v111, 1, v101
    v_mul_u32_u24 v110, 8256, v111
    v_bfe_u32 v111, v101, 2, 2
    v_lshl_add_u32 v111, v106, 2, v111
    v_lshl_add_u32 v110, v111, 4, v110
    v_bfe_u32 v111, v101, 1, 1
    v_lshl_add_u32 v110, v111, 3, v110
    v_add_u32 v110, 16384, v110
    v_and_b32 v111, 3, v101
    v_cmp_eq_u32 vcc, 0, v111
    v_mov_b32 v111, 66824
    v_mov_b32 v112, 66816
    s_nop 0
    v_cndmask_b32 v111, v111, v112, vcc
    v_bfe_u32 v112, v101, 4, 1
    v_cmp_eq_u32 vcc, 1, v112
    s_nop 1
    v_cndmask_b32 v110, v110, v111, vcc
    v_mov_b32 v117, 4096
    v_cndmask_b32 v117, v117, 0, vcc
    v_mov_b32 v119, 32896
    v_cndmask_b32 v119, v119, 0, vcc
    v_mov_b32 v76, 0x3f80
    v_mov_b32 v77, 0
    v_mov_b32 v78, 0
    v_mov_b32 v79, 0
    v_lshlrev_b32 v111, 4, v100
    v_add_u32 v111, 66816, v111
    v_cmp_gt_u32 vcc, 320, v100
    s_and_saveexec_b64 s[20:21], vcc
    ds_write_b128 v111, v[76:79]
    s_mov_b64 exec, s[20:21]
    v_mov_b32 v118, 71936
    ds_write_b32 v118, v77
    s_waitcnt vmcnt(8)
    s_nop 1
    v_max_f32_dpp v116, v116, v116 row_shr:1 row_mask:0xf bank_mask:0xf
    s_nop 1
    v_max_f32_dpp v116, v116, v116 row_shr:2 row_mask:0xf bank_mask:0xf
    s_nop 1
    v_max_f32_dpp v116, v116, v116 row_shr:4 row_mask:0xf bank_mask:0xf
    s_nop 1
    v_max_f32_dpp v116, v116, v116 row_shr:8 row_mask:0xf bank_mask:0xf
    s_nop 1
    v_max_f32_dpp v116, v116, v116 row_bcast:15 row_mask:0xa bank_mask:0xf
    s_nop 1
    v_max_f32_dpp v116, v116, v116 row_bcast:31 row_mask:0xc bank_mask:0xf
    s_nop 1
    v_readlane_b32 s22, v116, 63
    v_mov_b32 v112, 0
    s_mov_b32 s23, 0xffff0000
    v_lshlrev_b32 v113, 16, v64
    v_fmac_f32 v112, v113, v113
    v_and_b32 v113, s23, v64
    v_fmac_f32 v112, v113, v113
    v_lshlrev_b32 v113, 16, v65
    v_fmac_f32 v112, v113, v113
    v_and_b32 v113, s23, v65
    v_fmac_f32 v112, v113, v113
    v_lshlrev_b32 v113, 16, v66
    v_fmac_f32 v112, v113, v113
    v_and_b32 v113, s23, v66
    v_fmac_f32 v112, v113, v113
    v_lshlrev_b32 v113, 16, v67
    v_fmac_f32 v112, v113, v113
    v_and_b32 v113, s23, v67
    v_fmac_f32 v112, v113, v113
    v_mov_b32 v113, v112
    s_nop 1
    v_permlane32_swap_b32 v112, v113
    s_nop 1
    v_add_f32 v112, v112, v113
    v_mul_f32 v112, s22, v112
    v_sqrt_f32 v112, v112
    s_nop 0
    v_mul_f32 v112, 0xbf828f5c, v112
    v_mov_b32 v32, v112
    v_mov_b32 v48, 0
    v_mov_b32 v33, v112
    v_mov_b32 v49, 0
    v_mov_b32 v34, v112
    v_mov_b32 v50, 0
    v_mov_b32 v35, v112
    v_mov_b32 v51, 0
    v_mov_b32 v36, v112
    v_mov_b32 v52, 0
    v_mov_b32 v37, v112
    v_mov_b32 v53, 0
    v_mov_b32 v38, v112
    v_mov_b32 v54, 0
    v_mov_b32 v39, v112
    v_mov_b32 v55, 0
    v_mov_b32 v40, v112
    v_mov_b32 v56, 0
    v_mov_b32 v41, v112
    v_mov_b32 v57, 0
    v_mov_b32 v42, v112
    v_mov_b32 v58, 0
    v_mov_b32 v43, v112
    v_mov_b32 v59, 0
    v_mov_b32 v44, v112
    v_mov_b32 v60, 0
    v_mov_b32 v45, v112
    v_mov_b32 v61, 0
    v_mov_b32 v46, v112
    v_mov_b32 v62, 0
    v_mov_b32 v47, v112
    v_mov_b32 v63, 0
    s_waitcnt vmcnt(4)
    s_mov_b32 s17, 0
L_at_lp_7:
    s_bitcmp1_b32 s17, 0
    s_cbranch_scc1 L_at_g_8
    s_cmp_eq_u32 s17, 0
    s_cbranch_scc1 L_at_w_9
    s_waitcnt vmcnt(0)
L_at_w_9:
    s_waitcnt lgkmcnt(0)
    s_barrier
    s_lshr_b32 s37, s17, 1
    s_cmp_eq_u32 s37, 0
    s_cbranch_scc1 L_at_d_10
    s_cmp_eq_u32 s37, 3
    s_cbranch_scc1 L_at_d_10
    s_add_u32 s38, s37, 1
    s_lshl_b32 s34, s38, 13
    s_add_u32 s34, s34, s31
    s_and_b32 s35, s38, 1
    s_mul_i32 s35, s35, 32896
    s_add_u32 s35, s35, s32
    s_add_u32 m0, s35, 0
    s_add_u32 s36, s34, 0
    buffer_load_dwordx4 v103, s[24:27], s36 offen lds
    s_add_u32 m0, s35, 1024
    s_add_u32 s36, s34, 1024
    buffer_load_dwordx4 v103, s[24:27], s36 offen lds
    s_add_u32 m0, s35, 2048
    s_add_u32 s36, s34, 2048
    buffer_load_dwordx4 v103, s[24:27], s36 offen lds
    s_add_u32 m0, s35, 3072
    s_add_u32 s36, s34, 3072
    buffer_load_dwordx4 v103, s[24:27], s36 offen lds
L_at_d_10:
    s_and_b32 s37, s37, 1
    s_mul_i32 s38, s37, 32896
    v_add_u32 v114, s38, v109
    v_mul_lo_u32 v115, s37, v119
    v_add_u32 v115, v115, v110
    ds_read_b128 v[68:71], v114
    ds_read_b128 v[72:75], v114 offset:512
    ds_read_b64_tr_b16 v[76:77], v115 offset:0
    ds_read_b64_tr_b16 v[78:79], v115 offset:128
    ds_read_b64_tr_b16 v[80:81], v115 offset:256
    ds_read_b64_tr_b16 v[82:83], v115 offset:384
    s_waitcnt lgkmcnt(5)
    v_mfma_f32_32x32x16_bf16 v[0:15], v[68:71], v[64:67], v[32:47]
    s_nop 7
L_at_g_8:
    s_lshr_b32 s39, s12, 2
    s_xor_b32 s39, s39, s17
    s_bitcmp1_b32 s39, 0
    s_cbranch_scc1 L_at_pr_11
    s_setprio 0
    s_branch L_at_pr2_12
L_at_pr_11:
    s_setprio 1
L_at_pr2_12:
    ds_read_b128 v[68:71], v114 offset:1024
    ds_read_b64_tr_b16 v[84:85], v115 offset:512
    ds_read_b64_tr_b16 v[86:87], v115 offset:640
    ds_read_b64_tr_b16 v[88:89], v115 offset:768
    ds_read_b64_tr_b16 v[90:91], v115 offset:896
    s_waitcnt lgkmcnt(9)
    v_mfma_f32_32x32x16_bf16 v[16:31], v[72:75], v[64:67], v[32:47]
    v_exp_f32 v0, v0
    v_exp_f32 v1, v1
    v_exp_f32 v2, v2
    v_exp_f32 v3, v3
    v_exp_f32 v4, v4
    v_exp_f32 v5, v5
    v_exp_f32 v6, v6
    v_exp_f32 v7, v7
    v_cvt_pk_bf16_f32 v92, v0, v1
    v_cvt_pk_bf16_f32 v93, v2, v3
    v_cvt_pk_bf16_f32 v94, v4, v5
    v_cvt_pk_bf16_f32 v95, v6, v7
    s_waitcnt lgkmcnt(5)
    s_nop 0
    v_mfma_f32_32x32x16_bf16 v[48:63], v[76:79], v[92:95], v[48:63]
    v_exp_f32 v8, v8
    v_exp_f32 v9, v9
    v_exp_f32 v10, v10
    v_exp_f32 v11, v11
    v_exp_f32 v12, v12
    v_exp_f32 v13, v13
    v_exp_f32 v14, v14
    v_exp_f32 v15, v15
    v_cvt_pk_bf16_f32 v96, v8, v9
    v_cvt_pk_bf16_f32 v97, v10, v11
    v_cvt_pk_bf16_f32 v98, v12, v13
    v_cvt_pk_bf16_f32 v99, v14, v15
    s_nop 1
    v_mfma_f32_32x32x16_bf16 v[48:63], v[80:83], v[96:99], v[48:63]
    ds_read_b128 v[72:75], v114 offset:1536
    ds_read_b64_tr_b16 v[76:77], v115 offset:1024
    ds_read_b64_tr_b16 v[78:79], v115 offset:1152
    ds_read_b64_tr_b16 v[80:81], v115 offset:1280
    ds_read_b64_tr_b16 v[82:83], v115 offset:1408
    s_waitcnt lgkmcnt(9)
    v_mfma_f32_32x32x16_bf16 v[0:15], v[68:71], v[64:67], v[32:47]
    v_exp_f32 v16, v16
    v_exp_f32 v17, v17
    v_exp_f32 v18, v18
    v_exp_f32 v19, v19
    v_exp_f32 v20, v20
    v_exp_f32 v21, v21
    v_exp_f32 v22, v22
    v_exp_f32 v23, v23
    v_cvt_pk_bf16_f32 v92, v16, v17
    v_cvt_pk_bf16_f32 v93, v18, v19
    v_cvt_pk_bf16_f32 v94, v20, v21
    v_cvt_pk_bf16_f32 v95, v22, v23
    s_waitcnt lgkmcnt(5)
    s_nop 0
    v_mfma_f32_32x32x16_bf16 v[48:63], v[84:87], v[92:95], v[48:63]
    v_exp_f32 v24, v24
    v_exp_f32 v25, v25
    v_exp_f32 v26, v26
    v_exp_f32 v27, v27
    v_exp_f32 v28, v28
    v_exp_f32 v29, v29
    v_exp_f32 v30, v30
    v_exp_f32 v31, v31
    v_cvt_pk_bf16_f32 v96, v24, v25
    v_cvt_pk_bf16_f32 v97, v26, v27
    v_cvt_pk_bf16_f32 v98, v28, v29
    v_cvt_pk_bf16_f32 v99, v30, v31
    s_nop 1
    v_mfma_f32_32x32x16_bf16 v[48:63], v[88:91], v[96:99], v[48:63]
    ds_read_b128 v[68:71], v114 offset:2048
    ds_read_b64_tr_b16 v[84:85], v115 offset:1536
    ds_read_b64_tr_b16 v[86:87], v115 offset:1664
    ds_read_b64_tr_b16 v[88:89], v115 offset:1792
    ds_read_b64_tr_b16 v[90:91], v115 offset:1920
    s_waitcnt lgkmcnt(9)
    v_mfma_f32_32x32x16_bf16 v[16:31], v[72:75], v[64:67], v[32:47]
    v_exp_f32 v0, v0
    v_exp_f32 v1, v1
    v_exp_f32 v2, v2
    v_exp_f32 v3, v3
    v_exp_f32 v4, v4
    v_exp_f32 v5, v5
    v_exp_f32 v6, v6
    v_exp_f32 v7, v7
    v_cvt_pk_bf16_f32 v92, v0, v1
    v_cvt_pk_bf16_f32 v93, v2, v3
    v_cvt_pk_bf16_f32 v94, v4, v5
    v_cvt_pk_bf16_f32 v95, v6, v7
    s_waitcnt lgkmcnt(5)
    s_nop 0
    v_mfma_f32_32x32x16_bf16 v[48:63], v[76:79], v[92:95], v[48:63]
    v_exp_f32 v8, v8
    v_exp_f32 v9, v9
    v_exp_f32 v10, v10
    v_exp_f32 v11, v11
    v_exp_f32 v12, v12
    v_exp_f32 v13, v13
    v_exp_f32 v14, v14
    v_exp_f32 v15, v15
    v_cvt_pk_bf16_f32 v96, v8, v9
    v_cvt_pk_bf16_f32 v97, v10, v11
    v_cvt_pk_bf16_f32 v98, v12, v13
    v_cvt_pk_bf16_f32 v99, v14, v15
    s_nop 1
    v_mfma_f32_32x32x16_bf16 v[48:63], v[80:83], v[96:99], v[48:63]
    ds_read_b128 v[72:75], v114 offset:2560
    ds_read_b64_tr_b16 v[76:77], v115 offset:2048
    ds_read_b64_tr_b16 v[78:79], v115 offset:2176
    ds_read_b64_tr_b16 v[80:81], v115 offset:2304
    ds_read_b64_tr_b16 v[82:83], v115 offset:2432
    s_waitcnt lgkmcnt(9)
    v_mfma_f32_32x32x16_bf16 v[0:15], v[68:71], v[64:67], v[32:47]
    v_exp_f32 v16, v16
    v_exp_f32 v17, v17
    v_exp_f32 v18, v18
    v_exp_f32 v19, v19
    v_exp_f32 v20, v20
    v_exp_f32 v21, v21
    v_exp_f32 v22, v22
    v_exp_f32 v23, v23
    v_cvt_pk_bf16_f32 v92, v16, v17
    v_cvt_pk_bf16_f32 v93, v18, v19
    v_cvt_pk_bf16_f32 v94, v20, v21
    v_cvt_pk_bf16_f32 v95, v22, v23
    s_waitcnt lgkmcnt(5)
    s_nop 0
    v_mfma_f32_32x32x16_bf16 v[48:63], v[84:87], v[92:95], v[48:63]
    v_exp_f32 v24, v24
    v_exp_f32 v25, v25
    v_exp_f32 v26, v26
    v_exp_f32 v27, v27
    v_exp_f32 v28, v28
    v_exp_f32 v29, v29
    v_exp_f32 v30, v30
    v_exp_f32 v31, v31
    v_cvt_pk_bf16_f32 v96, v24, v25
    v_cvt_pk_bf16_f32 v97, v26, v27
    v_cvt_pk_bf16_f32 v98, v28, v29
    v_cvt_pk_bf16_f32 v99, v30, v31
    s_nop 1
    v_mfma_f32_32x32x16_bf16 v[48:63], v[88:91], v[96:99], v[48:63]
    ds_read_b128 v[68:71], v114 offset:3072
    ds_read_b64_tr_b16 v[84:85], v115 offset:2560
    ds_read_b64_tr_b16 v[86:87], v115 offset:2688
    ds_read_b64_tr_b16 v[88:89], v115 offset:2816
    ds_read_b64_tr_b16 v[90:91], v115 offset:2944
    s_waitcnt lgkmcnt(9)
    v_mfma_f32_32x32x16_bf16 v[16:31], v[72:75], v[64:67], v[32:47]
    v_exp_f32 v0, v0
    v_exp_f32 v1, v1
    v_exp_f32 v2, v2
    v_exp_f32 v3, v3
    v_exp_f32 v4, v4
    v_exp_f32 v5, v5
    v_exp_f32 v6, v6
    v_exp_f32 v7, v7
    v_cvt_pk_bf16_f32 v92, v0, v1
    v_cvt_pk_bf16_f32 v93, v2, v3
    v_cvt_pk_bf16_f32 v94, v4, v5
    v_cvt_pk_bf16_f32 v95, v6, v7
    s_waitcnt lgkmcnt(5)
    s_nop 0
    v_mfma_f32_32x32x16_bf16 v[48:63], v[76:79], v[92:95], v[48:63]
    v_exp_f32 v8, v8
    v_exp_f32 v9, v9
    v_exp_f32 v10, v10
    v_exp_f32 v11, v11
    v_exp_f32 v12, v12
    v_exp_f32 v13, v13
    v_exp_f32 v14, v14
    v_exp_f32 v15, v15
    v_cvt_pk_bf16_f32 v96, v8, v9
    v_cvt_pk_bf16_f32 v97, v10, v11
    v_cvt_pk_bf16_f32 v98, v12, v13
    v_cvt_pk_bf16_f32 v99, v14, v15
    s_nop 1
    v_mfma_f32_32x32x16_bf16 v[48:63], v[80:83], v[96:99], v[48:63]
    ds_read_b128 v[72:75], v114 offset:3584
    ds_read_b64_tr_b16 v[76:77], v115 offset:3072
    ds_read_b64_tr_b16 v[78:79], v115 offset:3200
    ds_read_b64_tr_b16 v[80:81], v115 offset:3328
    ds_read_b64_tr_b16 v[82:83], v115 offset:3456
    s_waitcnt lgkmcnt(9)
    v_mfma_f32_32x32x16_bf16 v[0:15], v[68:71], v[64:67], v[32:47]
    v_exp_f32 v16, v16
    v_exp_f32 v17, v17
    v_exp_f32 v18, v18
    v_exp_f32 v19, v19
    v_exp_f32 v20, v20
    v_exp_f32 v21, v21
    v_exp_f32 v22, v22
    v_exp_f32 v23, v23
    v_cvt_pk_bf16_f32 v92, v16, v17
    v_cvt_pk_bf16_f32 v93, v18, v19
    v_cvt_pk_bf16_f32 v94, v20, v21
    v_cvt_pk_bf16_f32 v95, v22, v23
    s_waitcnt lgkmcnt(5)
    s_nop 0
    v_mfma_f32_32x32x16_bf16 v[48:63], v[84:87], v[92:95], v[48:63]
    v_exp_f32 v24, v24
    v_exp_f32 v25, v25
    v_exp_f32 v26, v26
    v_exp_f32 v27, v27
    v_exp_f32 v28, v28
    v_exp_f32 v29, v29
    v_exp_f32 v30, v30
    v_exp_f32 v31, v31
    v_cvt_pk_bf16_f32 v96, v24, v25
    v_cvt_pk_bf16_f32 v97, v26, v27
    v_cvt_pk_bf16_f32 v98, v28, v29
    v_cvt_pk_bf16_f32 v99, v30, v31
    s_nop 1
    v_mfma_f32_32x32x16_bf16 v[48:63], v[88:91], v[96:99], v[48:63]
    ds_read_b128 v[68:71], v114 offset:4096
    ds_read_b64_tr_b16 v[84:85], v115 offset:3584
    ds_read_b64_tr_b16 v[86:87], v115 offset:3712
    ds_read_b64_tr_b16 v[88:89], v115 offset:3840
    ds_read_b64_tr_b16 v[90:91], v115 offset:3968
    s_waitcnt lgkmcnt(9)
    v_mfma_f32_32x32x16_bf16 v[16:31], v[72:75], v[64:67], v[32:47]
    v_exp_f32 v0, v0
    v_exp_f32 v1, v1
    v_exp_f32 v2, v2
    v_exp_f32 v3, v3
    v_exp_f32 v4, v4
    v_exp_f32 v5, v5
    v_exp_f32 v6, v6
    v_exp_f32 v7, v7
    v_cvt_pk_bf16_f32 v92, v0, v1
    v_cvt_pk_bf16_f32 v93, v2, v3
    v_cvt_pk_bf16_f32 v94, v4, v5
    v_cvt_pk_bf16_f32 v95, v6, v7
    s_waitcnt lgkmcnt(5)
    s_nop 0
    v_mfma_f32_32x32x16_bf16 v[48:63], v[76:79], v[92:95], v[48:63]
    v_exp_f32 v8, v8
    v_exp_f32 v9, v9
    v_exp_f32 v10, v10
    v_exp_f32 v11, v11
    v_exp_f32 v12, v12
    v_exp_f32 v13, v13
    v_exp_f32 v14, v14
    v_exp_f32 v15, v15
    v_cvt_pk_bf16_f32 v96, v8, v9
    v_cvt_pk_bf16_f32 v97, v10, v11
    v_cvt_pk_bf16_f32 v98, v12, v13
    v_cvt_pk_bf16_f32 v99, v14, v15
    s_nop 1
    v_mfma_f32_32x32x16_bf16 v[48:63], v[80:83], v[96:99], v[48:63]
    ds_read_b128 v[72:75], v114 offset:4608
    ds_read_b64_tr_b16 v[76:77], v115 offset:4096
    ds_read_b64_tr_b16 v[78:79], v115 offset:4224
    ds_read_b64_tr_b16 v[80:81], v115 offset:4352
    ds_read_b64_tr_b16 v[82:83], v115 offset:4480
    s_waitcnt lgkmcnt(9)
    v_mfma_f32_32x32x16_bf16 v[0:15], v[68:71], v[64:67], v[32:47]
    v_exp_f32 v16, v16
    v_exp_f32 v17, v17
    v_exp_f32 v18, v18
    v_exp_f32 v19, v19
    v_exp_f32 v20, v20
    v_exp_f32 v21, v21
    v_exp_f32 v22, v22
    v_exp_f32 v23, v23
    v_cvt_pk_bf16_f32 v92, v16, v17
    v_cvt_pk_bf16_f32 v93, v18, v19
    v_cvt_pk_bf16_f32 v94, v20, v21
    v_cvt_pk_bf16_f32 v95, v22, v23
    s_waitcnt lgkmcnt(5)
    s_nop 0
    v_mfma_f32_32x32x16_bf16 v[48:63], v[84:87], v[92:95], v[48:63]
    v_exp_f32 v24, v24
    v_exp_f32 v25, v25
    v_exp_f32 v26, v26
    v_exp_f32 v27, v27
    v_exp_f32 v28, v28
    v_exp_f32 v29, v29
    v_exp_f32 v30, v30
    v_exp_f32 v31, v31
    v_cvt_pk_bf16_f32 v96, v24, v25
    v_cvt_pk_bf16_f32 v97, v26, v27
    v_cvt_pk_bf16_f32 v98, v28, v29
    v_cvt_pk_bf16_f32 v99, v30, v31
    s_nop 1
    v_mfma_f32_32x32x16_bf16 v[48:63], v[88:91], v[96:99], v[48:63]
    v_add_u32 v114, 4096, v114
    v_add_u32 v115, v117, v115
    s_add_u32 s17, s17, 1
    s_cmp_lt_u32 s17, 8
    s_cbranch_scc1 L_at_lp_7
    s_waitcnt lgkmcnt(0)
    s_nop 15
    v_mov_b32 v112, v56
    v_mov_b32 v113, v56
    s_nop 1
    v_permlane32_swap_b32 v112, v113
    s_nop 1
    v_cmp_nle_f32 vcc, 0x1f800000, v112
    s_nop 1
    s_cbranch_vccz L_at_chk_13
    v_mov_b32 v113, 1
    ds_write_b32 v118, v113
    s_waitcnt lgkmcnt(0)
L_at_chk_13:
    s_barrier
    ds_read_b32 v113, v118
    s_waitcnt lgkmcnt(0)
    v_readfirstlane_b32 s33, v113
    s_nop 3
    s_cmp_eq_u32 s33, 0
    s_cbranch_scc1 L_at_fin_14
    v_mov_b32 v112, 0xff800000
    v_mov_b32 v113, 0xff800000
    s_add_u32 s34, s31, 0
    s_add_u32 s35, s32, 0
    s_add_u32 m0, s35, 0
    s_add_u32 s36, s34, 0
    buffer_load_dwordx4 v103, s[24:27], s36 offen lds
    s_add_u32 m0, s35, 1024
    s_add_u32 s36, s34, 1024
    buffer_load_dwordx4 v103, s[24:27], s36 offen lds
    s_add_u32 m0, s35, 2048
    s_add_u32 s36, s34, 2048
    buffer_load_dwordx4 v103, s[24:27], s36 offen lds
    s_add_u32 m0, s35, 3072
    s_add_u32 s36, s34, 3072
    buffer_load_dwordx4 v103, s[24:27], s36 offen lds
    s_add_u32 s34, s31, 8192
    s_add_u32 s35, s32, 32896
    s_add_u32 m0, s35, 0
    s_add_u32 s36, s34, 0
    buffer_load_dwordx4 v103, s[24:27], s36 offen lds
    s_add_u32 m0, s35, 1024
    s_add_u32 s36, s34, 1024
    buffer_load_dwordx4 v103, s[24:27], s36 offen lds
    s_add_u32 m0, s35, 2048
    s_add_u32 s36, s34, 2048
    buffer_load_dwordx4 v103, s[24:27], s36 offen lds
    s_add_u32 m0, s35, 3072
    s_add_u32 s36, s34, 3072
    buffer_load_dwordx4 v103, s[24:27], s36 offen lds
    s_waitcnt vmcnt(4)
    s_mov_b32 s17, 0
L_at_lp_15:
    s_bitcmp1_b32 s17, 0
    s_cbranch_scc1 L_at_g_16
    s_cmp_eq_u32 s17, 0
    s_cbranch_scc1 L_at_w_17
    s_waitcnt vmcnt(0)
L_at_w_17:
    s_waitcnt lgkmcnt(0)
    s_barrier
    s_lshr_b32 s37, s17, 1
    s_cmp_eq_u32 s37, 0
    s_cbranch_scc1 L_at_d_18
    s_cmp_eq_u32 s37, 3
    s_cbranch_scc1 L_at_d_18
    s_add_u32 s38, s37, 1
    s_lshl_b32 s34, s38, 13
    s_add_u32 s34, s34, s31
    s_and_b32 s35, s38, 1
    s_mul_i32 s35, s35, 32896
    s_add_u32 s35, s35, s32
    s_add_u32 m0, s35, 0
    s_add_u32 s36, s34, 0
    buffer_load_dwordx4 v103, s[24:27], s36 offen lds
    s_add_u32 m0, s35, 1024
    s_add_u32 s36, s34, 1024
    buffer_load_dwordx4 v103, s[24:27], s36 offen lds
    s_add_u32 m0, s35, 2048
    s_add_u32 s36, s34, 2048
    buffer_load_dwordx4 v103, s[24:27], s36 offen lds
    s_add_u32 m0, s35, 3072
    s_add_u32 s36, s34, 3072
    buffer_load_dwordx4 v103, s[24:27], s36 offen lds
L_at_d_18:
    s_and_b32 s37, s37, 1
    s_mul_i32 s38, s37, 32896
    v_add_u32 v114, s38, v109
    v_mul_lo_u32 v115, s37, v119
    v_add_u32 v115, v115, v110
    ds_read_b128 v[68:71], v114
    ds_read_b128 v[72:75], v114 offset:512
    s_waitcnt lgkmcnt(1)
    v_mfma_f32_32x32x16_bf16 v[0:15], v[68:71], v[64:67], 0
    s_nop 7
L_at_g_16:
    s_lshr_b32 s39, s12, 2
    s_xor_b32 s39, s39, s17
    s_bitcmp1_b32 s39, 0
    s_cbranch_scc1 L_at_pr_19
    s_setprio 0
    s_branch L_at_pr2_20
L_at_pr_19:
    s_setprio 1
L_at_pr2_20:
    ds_read_b128 v[68:71], v114 offset:1024
    s_waitcnt lgkmcnt(1)
    v_mfma_f32_32x32x16_bf16 v[16:31], v[72:75], v[64:67], 0
    s_nop 1
    v_max3_f32 v112, v0, v1, v112
    v_max3_f32 v113, v2, v3, v113
    v_max3_f32 v112, v4, v5, v112
    v_max3_f32 v113, v6, v7, v113
    v_max3_f32 v112, v8, v9, v112
    v_max3_f32 v113, v10, v11, v113
    v_max3_f32 v112, v12, v13, v112
    v_max3_f32 v113, v14, v15, v113
    ds_read_b128 v[72:75], v114 offset:1536
    s_waitcnt lgkmcnt(1)
    v_mfma_f32_32x32x16_bf16 v[0:15], v[68:71], v[64:67], 0
    s_nop 1
    v_max3_f32 v112, v16, v17, v112
    v_max3_f32 v113, v18, v19, v113
    v_max3_f32 v112, v20, v21, v112
    v_max3_f32 v113, v22, v23, v113
    v_max3_f32 v112, v24, v25, v112
    v_max3_f32 v113, v26, v27, v113
    v_max3_f32 v112, v28, v29, v112
    v_max3_f32 v113, v30, v31, v113
    ds_read_b128 v[68:71], v114 offset:2048
    s_waitcnt lgkmcnt(1)
    v_mfma_f32_32x32x16_bf16 v[16:31], v[72:75], v[64:67], 0
    s_nop 1
    v_max3_f32 v112, v0, v1, v112
    v_max3_f32 v113, v2, v3, v113
    v_max3_f32 v112, v4, v5, v112
    v_max3_f32 v113, v6, v7, v113
    v_max3_f32 v112, v8, v9, v112
    v_max3_f32 v113, v10, v11, v113
    v_max3_f32 v112, v12, v13, v112
    v_max3_f32 v113, v14, v15, v113
    ds_read_b128 v[72:75], v114 offset:2560
    s_waitcnt lgkmcnt(1)
    v_mfma_f32_32x32x16_bf16 v[0:15], v[68:71], v[64:67], 0
    s_nop 1
    v_max3_f32 v112, v16, v17, v112
    v_max3_f32 v113, v18, v19, v113
    v_max3_f32 v112, v20, v21, v112
    v_max3_f32 v113, v22, v23, v113
    v_max3_f32 v112, v24, v25, v112
    v_max3_f32 v113, v26, v27, v113
    v_max3_f32 v112, v28, v29, v112
    v_max3_f32 v113, v30, v31, v113
    ds_read_b128 v[68:71], v114 offset:3072
    s_waitcnt lgkmcnt(1)
    v_mfma_f32_32x32x16_bf16 v[16:31], v[72:75], v[64:67], 0
    s_nop 1
    v_max3_f32 v112, v0, v1, v112
    v_max3_f32 v113, v2, v3, v113
    v_max3_f32 v112, v4, v5, v112
    v_max3_f32 v113, v6, v7, v113
    v_max3_f32 v112, v8, v9, v112
    v_max3_f32 v113, v10, v11, v113
    v_max3_f32 v112, v12, v13, v112
    v_max3_f32 v113, v14, v15, v113
    ds_read_b128 v[72:75], v114 offset:3584
    s_waitcnt lgkmcnt(1)
    v_mfma_f32_32x32x16_bf16 v[0:15], v[68:71], v[64:67], 0
    s_nop 1
    v_max3_f32 v112, v16, v17, v112
    v_max3_f32 v113, v18, v19, v113
    v_max3_f32 v112, v20, v21, v112
    v_max3_f32 v113, v22, v23, v113
    v_max3_f32 v112, v24, v25, v112
    v_max3_f32 v113, v26, v27, v113
    v_max3_f32 v112, v28, v29, v112
    v_max3_f32 v113, v30, v31, v113
    ds_read_b128 v[68:71], v114 offset:4096
    s_waitcnt lgkmcnt(1)
    v_mfma_f32_32x32x16_bf16 v[16:31], v[72:75], v[64:67], 0
    s_nop 1
    v_max3_f32 v112, v0, v1, v112
    v_max3_f32 v113, v2, v3, v113
    v_max3_f32 v112, v4, v5, v112
    v_max3_f32 v113, v6, v7, v113
    v_max3_f32 v112, v8, v9, v112
    v_max3_f32 v113, v10, v11, v113
    v_max3_f32 v112, v12, v13, v112
    v_max3_f32 v113, v14, v15, v113
    ds_read_b128 v[72:75], v114 offset:4608
    s_waitcnt lgkmcnt(1)
    v_mfma_f32_32x32x16_bf16 v[0:15], v[68:71], v[64:67], 0
    s_nop 1
    v_max3_f32 v112, v16, v17, v112
    v_max3_f32 v113, v18, v19, v113
    v_max3_f32 v112, v20, v21, v112
    v_max3_f32 v113, v22, v23, v113
    v_max3_f32 v112, v24, v25, v112
    v_max3_f32 v113, v26, v27, v113
    v_max3_f32 v112, v28, v29, v112
    v_max3_f32 v113, v30, v31, v113
    v_add_u32 v114, 4096, v114
    v_add_u32 v115, v117, v115
    s_add_u32 s17, s17, 1
    s_cmp_lt_u32 s17, 8
    s_cbranch_scc1 L_at_lp_15
    s_waitcnt lgkmcnt(0)
    s_nop 15
    v_max_f32 v112, v112, v113
    v_mov_b32 v113, v112
    s_nop 1
    v_permlane32_swap_b32 v112, v113
    s_nop 1
    v_max_f32 v112, v112, v113
    s_nop 3
    v_sub_f32 v32, 0, v112
    v_mov_b32 v48, 0
    v_sub_f32 v33, 0, v112
    v_mov_b32 v49, 0
    v_sub_f32 v34, 0, v112
    v_mov_b32 v50, 0
    v_sub_f32 v35, 0, v112
    v_mov_b32 v51, 0
    v_sub_f32 v36, 0, v112
    v_mov_b32 v52, 0
    v_sub_f32 v37, 0, v112
    v_mov_b32 v53, 0
    v_sub_f32 v38, 0, v112
    v_mov_b32 v54, 0
    v_sub_f32 v39, 0, v112
    v_mov_b32 v55, 0
    v_sub_f32 v40, 0, v112
    v_mov_b32 v56, 0
    v_sub_f32 v41, 0, v112
    v_mov_b32 v57, 0
    v_sub_f32 v42, 0, v112
    v_mov_b32 v58, 0
    v_sub_f32 v43, 0, v112
    v_mov_b32 v59, 0
    v_sub_f32 v44, 0, v112
    v_mov_b32 v60, 0
    v_sub_f32 v45, 0, v112
    v_mov_b32 v61, 0
    v_sub_f32 v46, 0, v112
    v_mov_b32 v62, 0
    v_sub_f32 v47, 0, v112
    v_mov_b32 v63, 0
    s_barrier
    s_add_u32 s34, s31, 0
    s_add_u32 s35, s32, 0
    s_add_u32 m0, s35, 0
    s_add_u32 s36, s34, 0
    buffer_load_dwordx4 v103, s[24:27], s36 offen lds
    s_add_u32 m0, s35, 1024
    s_add_u32 s36, s34, 1024
    buffer_load_dwordx4 v103, s[24:27], s36 offen lds
    s_add_u32 m0, s35, 2048
    s_add_u32 s36, s34, 2048
    buffer_load_dwordx4 v103, s[24:27], s36 offen lds
    s_add_u32 m0, s35, 3072
    s_add_u32 s36, s34, 3072
    buffer_load_dwordx4 v103, s[24:27], s36 offen lds
    s_add_u32 s34, s31, 8192
    s_add_u32 s35, s32, 32896
    s_add_u32 m0, s35, 0
    s_add_u32 s36, s34, 0
    buffer_load_dwordx4 v103, s[24:27], s36 offen lds
    s_add_u32 m0, s35, 1024
    s_add_u32 s36, s34, 1024
    buffer_load_dwordx4 v103, s[24:27], s36 offen lds
    s_add_u32 m0, s35, 2048
    s_add_u32 s36, s34, 2048
    buffer_load_dwordx4 v103, s[24:27], s36 offen lds
    s_add_u32 m0, s35, 3072
    s_add_u32 s36, s34, 3072
    buffer_load_dwordx4 v103, s[24:27], s36 offen lds
    s_waitcnt vmcnt(4)
    s_mov_b32 s17, 0
L_at_lp_21:
    s_bitcmp1_b32 s17, 0
    s_cbranch_scc1 L_at_g_22
    s_cmp_eq_u32 s17, 0
    s_cbranch_scc1 L_at_w_23
    s_waitcnt vmcnt(0)
L_at_w_23:
    s_waitcnt lgkmcnt(0)
    s_barrier
    s_lshr_b32 s37, s17, 1
    s_cmp_eq_u32 s37, 0
    s_cbranch_scc1 L_at_d_24
    s_cmp_eq_u32 s37, 3
    s_cbranch_scc1 L_at_d_24
    s_add_u32 s38, s37, 1
    s_lshl_b32 s34, s38, 13
    s_add_u32 s34, s34, s31
    s_and_b32 s35, s38, 1
    s_mul_i32 s35, s35, 32896
    s_add_u32 s35, s35, s32
    s_add_u32 m0, s35, 0
    s_add_u32 s36, s34, 0
    buffer_load_dwordx4 v103, s[24:27], s36 offen lds
    s_add_u32 m0, s35, 1024
    s_add_u32 s36, s34, 1024
    buffer_load_dwordx4 v103, s[24:27], s36 offen lds
    s_add_u32 m0, s35, 2048
    s_add_u32 s36, s34, 2048
    buffer_load_dwordx4 v103, s[24:27], s36 offen lds
    s_add_u32 m0, s35, 3072
    s_add_u32 s36, s34, 3072
    buffer_load_dwordx4 v103, s[24:27], s36 offen lds
L_at_d_24:
    s_and_b32 s37, s37, 1
    s_mul_i32 s38, s37, 32896
    v_add_u32 v114, s38, v109
    v_mul_lo_u32 v115, s37, v119
    v_add_u32 v115, v115, v110
    ds_read_b128 v[68:71], v114
    ds_read_b128 v[72:75], v114 offset:512
    ds_read_b64_tr_b16 v[76:77], v115 offset:0
    ds_read_b64_tr_b16 v[78:79], v115 offset:128
    ds_read_b64_tr_b16 v[80:81], v115 offset:256
    ds_read_b64_tr_b16 v[82:83], v115 offset:384
    s_waitcnt lgkmcnt(5)
    v_mfma_f32_32x32x16_bf16 v[0:15], v[68:71], v[64:67], v[32:47]
    s_nop 7
L_at_g_22:
    s_lshr_b32 s39, s12, 2
    s_xor_b32 s39, s39, s17
    s_bitcmp1_b32 s39, 0
    s_cbranch_scc1 L_at_pr_25
    s_setprio 0
    s_branch L_at_pr2_26
L_at_pr_25:
    s_setprio 1
L_at_pr2_26:
    ds_read_b128 v[68:71], v114 offset:1024
    ds_read_b64_tr_b16 v[84:85], v115 offset:512
    ds_read_b64_tr_b16 v[86:87], v115 offset:640
    ds_read_b64_tr_b16 v[88:89], v115 offset:768
    ds_read_b64_tr_b16 v[90:91], v115 offset:896
    s_waitcnt lgkmcnt(9)
    v_mfma_f32_32x32x16_bf16 v[16:31], v[72:75], v[64:67], v[32:47]
    v_exp_f32 v0, v0
    v_exp_f32 v1, v1
    v_exp_f32 v2, v2
    v_exp_f32 v3, v3
    v_exp_f32 v4, v4
    v_exp_f32 v5, v5
    v_exp_f32 v6, v6
    v_exp_f32 v7, v7
    v_cvt_pk_bf16_f32 v92, v0, v1
    v_cvt_pk_bf16_f32 v93, v2, v3
    v_cvt_pk_bf16_f32 v94, v4, v5
    v_cvt_pk_bf16_f32 v95, v6, v7
    s_waitcnt lgkmcnt(5)
    s_nop 0
    v_mfma_f32_32x32x16_bf16 v[48:63], v[76:79], v[92:95], v[48:63]
    v_exp_f32 v8, v8
    v_exp_f32 v9, v9
    v_exp_f32 v10, v10
    v_exp_f32 v11, v11
    v_exp_f32 v12, v12
    v_exp_f32 v13, v13
    v_exp_f32 v14, v14
    v_exp_f32 v15, v15
    v_cvt_pk_bf16_f32 v96, v8, v9
    v_cvt_pk_bf16_f32 v97, v10, v11
    v_cvt_pk_bf16_f32 v98, v12, v13
    v_cvt_pk_bf16_f32 v99, v14, v15
    s_nop 1
    v_mfma_f32_32x32x16_bf16 v[48:63], v[80:83], v[96:99], v[48:63]
    ds_read_b128 v[72:75], v114 offset:1536
    ds_read_b64_tr_b16 v[76:77], v115 offset:1024
    ds_read_b64_tr_b16 v[78:79], v115 offset:1152
    ds_read_b64_tr_b16 v[80:81], v115 offset:1280
    ds_read_b64_tr_b16 v[82:83], v115 offset:1408
    s_waitcnt lgkmcnt(9)
    v_mfma_f32_32x32x16_bf16 v[0:15], v[68:71], v[64:67], v[32:47]
    v_exp_f32 v16, v16
    v_exp_f32 v17, v17
    v_exp_f32 v18, v18
    v_exp_f32 v19, v19
    v_exp_f32 v20, v20
    v_exp_f32 v21, v21
    v_exp_f32 v22, v22
    v_exp_f32 v23, v23
    v_cvt_pk_bf16_f32 v92, v16, v17
    v_cvt_pk_bf16_f32 v93, v18, v19
    v_cvt_pk_bf16_f32 v94, v20, v21
    v_cvt_pk_bf16_f32 v95, v22, v23
    s_waitcnt lgkmcnt(5)
    s_nop 0
    v_mfma_f32_32x32x16_bf16 v[48:63], v[84:87], v[92:95], v[48:63]
    v_exp_f32 v24, v24
    v_exp_f32 v25, v25
    v_exp_f32 v26, v26
    v_exp_f32 v27, v27
    v_exp_f32 v28, v28
    v_exp_f32 v29, v29
    v_exp_f32 v30, v30
    v_exp_f32 v31, v31
    v_cvt_pk_bf16_f32 v96, v24, v25
    v_cvt_pk_bf16_f32 v97, v26, v27
    v_cvt_pk_bf16_f32 v98, v28, v29
    v_cvt_pk_bf16_f32 v99, v30, v31
    s_nop 1
    v_mfma_f32_32x32x16_bf16 v[48:63], v[88:91], v[96:99], v[48:63]
    ds_read_b128 v[68:71], v114 offset:2048
    ds_read_b64_tr_b16 v[84:85], v115 offset:1536
    ds_read_b64_tr_b16 v[86:87], v115 offset:1664
    ds_read_b64_tr_b16 v[88:89], v115 offset:1792
    ds_read_b64_tr_b16 v[90:91], v115 offset:1920
    s_waitcnt lgkmcnt(9)
    v_mfma_f32_32x32x16_bf16 v[16:31], v[72:75], v[64:67], v[32:47]
    v_exp_f32 v0, v0
    v_exp_f32 v1, v1
    v_exp_f32 v2, v2
    v_exp_f32 v3, v3
    v_exp_f32 v4, v4
    v_exp_f32 v5, v5
    v_exp_f32 v6, v6
    v_exp_f32 v7, v7
    v_cvt_pk_bf16_f32 v92, v0, v1
    v_cvt_pk_bf16_f32 v93, v2, v3
    v_cvt_pk_bf16_f32 v94, v4, v5
    v_cvt_pk_bf16_f32 v95, v6, v7
    s_waitcnt lgkmcnt(5)
    s_nop 0
    v_mfma_f32_32x32x16_bf16 v[48:63], v[76:79], v[92:95], v[48:63]
    v_exp_f32 v8, v8
    v_exp_f32 v9, v9
    v_exp_f32 v10, v10
    v_exp_f32 v11, v11
    v_exp_f32 v12, v12
    v_exp_f32 v13, v13
    v_exp_f32 v14, v14
    v_exp_f32 v15, v15
    v_cvt_pk_bf16_f32 v96, v8, v9
    v_cvt_pk_bf16_f32 v97, v10, v11
    v_cvt_pk_bf16_f32 v98, v12, v13
    v_cvt_pk_bf16_f32 v99, v14, v15
    s_nop 1
    v_mfma_f32_32x32x16_bf16 v[48:63], v[80:83], v[96:99], v[48:63]
    ds_read_b128 v[72:75], v114 offset:2560
    ds_read_b64_tr_b16 v[76:77], v115 offset:2048
    ds_read_b64_tr_b16 v[78:79], v115 offset:2176
    ds_read_b64_tr_b16 v[80:81], v115 offset:2304
    ds_read_b64_tr_b16 v[82:83], v115 offset:2432
    s_waitcnt lgkmcnt(9)
    v_mfma_f32_32x32x16_bf16 v[0:15], v[68:71], v[64:67], v[32:47]
    v_exp_f32 v16, v16
    v_exp_f32 v17, v17
    v_exp_f32 v18, v18
    v_exp_f32 v19, v19
    v_exp_f32 v20, v20
    v_exp_f32 v21, v21
    v_exp_f32 v22, v22
    v_exp_f32 v23, v23
    v_cvt_pk_bf16_f32 v92, v16, v17
    v_cvt_pk_bf16_f32 v93, v18, v19
    v_cvt_pk_bf16_f32 v94, v20, v21
    v_cvt_pk_bf16_f32 v95, v22, v23
    s_waitcnt lgkmcnt(5)
    s_nop 0
    v_mfma_f32_32x32x16_bf16 v[48:63], v[84:87], v[92:95], v[48:63]
    v_exp_f32 v24, v24
    v_exp_f32 v25, v25
    v_exp_f32 v26, v26
    v_exp_f32 v27, v27
    v_exp_f32 v28, v28
    v_exp_f32 v29, v29
    v_exp_f32 v30, v30
    v_exp_f32 v31, v31
    v_cvt_pk_bf16_f32 v96, v24, v25
    v_cvt_pk_bf16_f32 v97, v26, v27
    v_cvt_pk_bf16_f32 v98, v28, v29
    v_cvt_pk_bf16_f32 v99, v30, v31
    s_nop 1
    v_mfma_f32_32x32x16_bf16 v[48:63], v[88:91], v[96:99], v[48:63]
    ds_read_b128 v[68:71], v114 offset:3072
    ds_read_b64_tr_b16 v[84:85], v115 offset:2560
    ds_read_b64_tr_b16 v[86:87], v115 offset:2688
    ds_read_b64_tr_b16 v[88:89], v115 offset:2816
    ds_read_b64_tr_b16 v[90:91], v115 offset:2944
    s_waitcnt lgkmcnt(9)
    v_mfma_f32_32x32x16_bf16 v[16:31], v[72:75], v[64:67], v[32:47]
    v_exp_f32 v0, v0
    v_exp_f32 v1, v1
    v_exp_f32 v2, v2
    v_exp_f32 v3, v3
    v_exp_f32 v4, v4
    v_exp_f32 v5, v5
    v_exp_f32 v6, v6
    v_exp_f32 v7, v7
    v_cvt_pk_bf16_f32 v92, v0, v1
    v_cvt_pk_bf16_f32 v93, v2, v3
    v_cvt_pk_bf16_f32 v94, v4, v5
    v_cvt_pk_bf16_f32 v95, v6, v7
    s_waitcnt lgkmcnt(5)
    s_nop 0
    v_mfma_f32_32x32x16_bf16 v[48:63], v[76:79], v[92:95], v[48:63]
    v_exp_f32 v8, v8
    v_exp_f32 v9, v9
    v_exp_f32 v10, v10
    v_exp_f32 v11, v11
    v_exp_f32 v12, v12
    v_exp_f32 v13, v13
    v_exp_f32 v14, v14
    v_exp_f32 v15, v15
    v_cvt_pk_bf16_f32 v96, v8, v9
    v_cvt_pk_bf16_f32 v97, v10, v11
    v_cvt_pk_bf16_f32 v98, v12, v13
    v_cvt_pk_bf16_f32 v99, v14, v15
    s_nop 1
    v_mfma_f32_32x32x16_bf16 v[48:63], v[80:83], v[96:99], v[48:63]
    ds_read_b128 v[72:75], v114 offset:3584
    ds_read_b64_tr_b16 v[76:77], v115 offset:3072
    ds_read_b64_tr_b16 v[78:79], v115 offset:3200
    ds_read_b64_tr_b16 v[80:81], v115 offset:3328
    ds_read_b64_tr_b16 v[82:83], v115 offset:3456
    s_waitcnt lgkmcnt(9)
    v_mfma_f32_32x32x16_bf16 v[0:15], v[68:71], v[64:67], v[32:47]
    v_exp_f32 v16, v16
    v_exp_f32 v17, v17
    v_exp_f32 v18, v18
    v_exp_f32 v19, v19
    v_exp_f32 v20, v20
    v_exp_f32 v21, v21
    v_exp_f32 v22, v22
    v_exp_f32 v23, v23
    v_cvt_pk_bf16_f32 v92, v16, v17
    v_cvt_pk_bf16_f32 v93, v18, v19
    v_cvt_pk_bf16_f32 v94, v20, v21
    v_cvt_pk_bf16_f32 v95, v22, v23
    s_waitcnt lgkmcnt(5)
    s_nop 0
    v_mfma_f32_32x32x16_bf16 v[48:63], v[84:87], v[92:95], v[48:63]
    v_exp_f32 v24, v24
    v_exp_f32 v25, v25
    v_exp_f32 v26, v26
    v_exp_f32 v27, v27
    v_exp_f32 v28, v28
    v_exp_f32 v29, v29
    v_exp_f32 v30, v30
    v_exp_f32 v31, v31
    v_cvt_pk_bf16_f32 v96, v24, v25
    v_cvt_pk_bf16_f32 v97, v26, v27
    v_cvt_pk_bf16_f32 v98, v28, v29
    v_cvt_pk_bf16_f32 v99, v30, v31
    s_nop 1
    v_mfma_f32_32x32x16_bf16 v[48:63], v[88:91], v[96:99], v[48:63]
    ds_read_b128 v[68:71], v114 offset:4096
    ds_read_b64_tr_b16 v[84:85], v115 offset:3584
    ds_read_b64_tr_b16 v[86:87], v115 offset:3712
    ds_read_b64_tr_b16 v[88:89], v115 offset:3840
    ds_read_b64_tr_b16 v[90:91], v115 offset:3968
    s_waitcnt lgkmcnt(9)
    v_mfma_f32_32x32x16_bf16 v[16:31], v[72:75], v[64:67], v[32:47]
    v_exp_f32 v0, v0
    v_exp_f32 v1, v1
    v_exp_f32 v2, v2
    v_exp_f32 v3, v3
    v_exp_f32 v4, v4
    v_exp_f32 v5, v5
    v_exp_f32 v6, v6
    v_exp_f32 v7, v7
    v_cvt_pk_bf16_f32 v92, v0, v1
    v_cvt_pk_bf16_f32 v93, v2, v3
    v_cvt_pk_bf16_f32 v94, v4, v5
    v_cvt_pk_bf16_f32 v95, v6, v7
    s_waitcnt lgkmcnt(5)
    s_nop 0
    v_mfma_f32_32x32x16_bf16 v[48:63], v[76:79], v[92:95], v[48:63]
    v_exp_f32 v8, v8
    v_exp_f32 v9, v9
    v_exp_f32 v10, v10
    v_exp_f32 v11, v11
    v_exp_f32 v12, v12
    v_exp_f32 v13, v13
    v_exp_f32 v14, v14
    v_exp_f32 v15, v15
    v_cvt_pk_bf16_f32 v96, v8, v9
    v_cvt_pk_bf16_f32 v97, v10, v11
    v_cvt_pk_bf16_f32 v98, v12, v13
    v_cvt_pk_bf16_f32 v99, v14, v15
    s_nop 1
    v_mfma_f32_32x32x16_bf16 v[48:63], v[80:83], v[96:99], v[48:63]
    ds_read_b128 v[72:75], v114 offset:4608
    ds_read_b64_tr_b16 v[76:77], v115 offset:4096
    ds_read_b64_tr_b16 v[78:79], v115 offset:4224
    ds_read_b64_tr_b16 v[80:81], v115 offset:4352
    ds_read_b64_tr_b16 v[82:83], v115 offset:4480
    s_waitcnt lgkmcnt(9)
    v_mfma_f32_32x32x16_bf16 v[0:15], v[68:71], v[64:67], v[32:47]
    v_exp_f32 v16, v16
    v_exp_f32 v17, v17
    v_exp_f32 v18, v18
    v_exp_f32 v19, v19
    v_exp_f32 v20, v20
    v_exp_f32 v21, v21
    v_exp_f32 v22, v22
    v_exp_f32 v23, v23
    v_cvt_pk_bf16_f32 v92, v16, v17
    v_cvt_pk_bf16_f32 v93, v18, v19
    v_cvt_pk_bf16_f32 v94, v20, v21
    v_cvt_pk_bf16_f32 v95, v22, v23
    s_waitcnt lgkmcnt(5)
    s_nop 0
    v_mfma_f32_32x32x16_bf16 v[48:63], v[84:87], v[92:95], v[48:63]
    v_exp_f32 v24, v24
    v_exp_f32 v25, v25
    v_exp_f32 v26, v26
    v_exp_f32 v27, v27
    v_exp_f32 v28, v28
    v_exp_f32 v29, v29
    v_exp_f32 v30, v30
    v_exp_f32 v31, v31
    v_cvt_pk_bf16_f32 v96, v24, v25
    v_cvt_pk_bf16_f32 v97, v26, v27
    v_cvt_pk_bf16_f32 v98, v28, v29
    v_cvt_pk_bf16_f32 v99, v30, v31
    s_nop 1
    v_mfma_f32_32x32x16_bf16 v[48:63], v[88:91], v[96:99], v[48:63]
    v_add_u32 v114, 4096, v114
    v_add_u32 v115, v117, v115
    s_add_u32 s17, s17, 1
    s_cmp_lt_u32 s17, 8
    s_cbranch_scc1 L_at_lp_21
    s_waitcnt lgkmcnt(0)
    s_nop 15
    v_mov_b32 v112, v56
    v_mov_b32 v113, v56
    s_nop 1
    v_permlane32_swap_b32 v112, v113
    s_nop 1
L_at_fin_14:
    v_rcp_f32 v112, v112
    s_nop 1
    v_mul_f32 v48, v48, v112
    v_mul_f32 v49, v49, v112
    v_mul_f32 v50, v50, v112
    v_mul_f32 v51, v51, v112
    v_mul_f32 v52, v52, v112
    v_mul_f32 v53, v53, v112
    v_mul_f32 v54, v54, v112
    v_mul_f32 v55, v55, v112
    v_cvt_pk_bf16_f32 v92, v48, v49
    v_cvt_pk_bf16_f32 v93, v50, v51
    v_cvt_pk_bf16_f32 v94, v52, v53
    v_cvt_pk_bf16_f32 v95, v54, v55
    s_add_u32 s14, s13, 6291456
    buffer_store_dwordx4 v[92:95], v108, s[24:27], s14 offen nt
L_at_end_6:
    s_endpgm
L_mid_s4d_5:
    v_cmp_gt_u32 vcc, 256, v0
    s_nop 1
    s_cbranch_vccz L_mid_exit_27
    s_setprio 1
    s_cmp_ge_u32 s2, 512
    s_cbranch_scc1 L_s4_end_28
    s_sub_u32 s2, s2, 256
    s_load_dwordx4 s[4:7], s[0:1], 0
    s_load_dwordx4 s[8:11], s[0:1], 16
    s_load_dwordx4 s[12:15], s[0:1], 32
    s_load_dwordx2 s[16:17], s[0:1], 48
    s_load_dwordx2 s[18:19], s[0:1], 80
    s_and_b32 s20, s2, 7
    s_lshl_b32 s20, s20, 5
    s_lshr_b32 s21, s2, 3
    s_add_u32 s20, s20, s21
    s_lshl_b32 s20, s20, 1
    v_mov_b32 v0, v0
    v_and_b32 v1, 63, v0
    v_lshrrev_b32 v4, 6, v0
    v_lshrrev_b32 v2, 7, v0
    v_and_b32 v3, 127, v0
    s_nop 0
    v_readfirstlane_b32 s22, v4
    s_waitcnt lgkmcnt(0)
    s_lshr_b32 s23, s22, 1
    s_and_b32 s24, s22, 1
    s_mov_b32 s28, s4
    s_and_b32 s29, s5, 0xffff
    s_mov_b32 s30, 2097152
    s_mov_b32 s31, 0x00020000
    s_mov_b32 s32, s6
    s_and_b32 s33, s7, 0xffff
    s_mov_b32 s34, 131072
    s_mov_b32 s35, 0x00020000
    s_mov_b32 s36, s8
    s_and_b32 s37, s9, 0xffff
    s_mov_b32 s38, 131072
    s_mov_b32 s39, 0x00020000
    s_mov_b32 s40, s10
    s_and_b32 s41, s11, 0xffff
    s_mov_b32 s42, 131072
    s_mov_b32 s43, 0x00020000
    s_mov_b32 s44, s12
    s_and_b32 s45, s13, 0xffff
    s_mov_b32 s46, 131072
    s_mov_b32 s47, 0x00020000
    s_mov_b32 s48, s14
    s_and_b32 s49, s15, 0xffff
    s_mov_b32 s50, 1024
    s_mov_b32 s51, 0x00020000
    s_mov_b32 s52, s16
    s_and_b32 s53, s17, 0xffff
    s_mov_b32 s54, 1024
    s_mov_b32 s55, 0x00020000
    s_mov_b32 s56, s18
    s_and_b32 s57, s19, 0xffff
    s_mov_b32 s58, 4194304
    s_mov_b32 s59, 0x00020000
    s_add_u32 s25, s20, s23
    s_lshl_b32 s26, s25, 8
    v_lshlrev_b32 v4, 1, v3
    v_xor_b32 v6, 128, v4
    buffer_load_ushort v18, v4, s[32:35], s26 offen
    buffer_load_ushort v19, v4, s[36:39], s26 offen
    buffer_load_ushort v20, v4, s[40:43], s26 offen
    buffer_load_ushort v21, v4, s[44:47], s26 offen
    buffer_load_ushort v23, v6, s[40:43], s26 offen
    buffer_load_ushort v24, v6, s[44:47], s26 offen
    s_lshl_b32 s26, s25, 1
    v_mov_b32 v5, 0
    buffer_load_ushort v22, v5, s[48:51], s26 offen
    buffer_load_ushort v8, v5, s[52:55], s26 offen
    v_lshlrev_b32 v6, 10, v0
    s_lshl_b32 s26, s20, 1
    buffer_load_dword v10, v6, s[28:31], s26 offen
    s_add_u32 s26, s26, 262144
    buffer_load_dword v11, v6, s[28:31], s26 offen
    s_add_u32 s26, s26, 262144
    buffer_load_dword v12, v6, s[28:31], s26 offen
    s_add_u32 s26, s26, 262144
    buffer_load_dword v13, v6, s[28:31], s26 offen
    s_add_u32 s26, s26, 262144
    buffer_load_dword v14, v6, s[28:31], s26 offen
    s_add_u32 s26, s26, 262144
    buffer_load_dword v15, v6, s[28:31], s26 offen
    s_add_u32 s26, s26, 262144
    buffer_load_dword v16, v6, s[28:31], s26 offen
    s_add_u32 s26, s26, 262144
    buffer_load_dword v17, v6, s[28:31], s26 offen
    s_mov_b32 s60, 0x3fb8aa3b
    s_mov_b32 s61, 0x32a57060
    s_mov_b32 s62, 0x3f317218
    s_mov_b32 s63, 0x3e22f983
    s_mov_b32 s64, 0x31dc9c88
    s_mov_b32 s65, 0xffff0000
    s_waitcnt vmcnt(8)
    v_lshlrev_b32 v18, 16, v18
    v_lshlrev_b32 v19, 16, v19
    v_lshlrev_b32 v20, 16, v20
    v_lshlrev_b32 v21, 16, v21
    v_lshlrev_b32 v22, 16, v22
    v_lshlrev_b32 v8, 16, v8
    v_lshlrev_b32 v23, 16, v23
    v_lshlrev_b32 v24, 16, v24
    v_mul_f32 v4, s60, v22
    v_fma_f32 v5, v22, s60, -v4
    v_fmac_f32 v5, s61, v22
    v_exp_f32 v4, v4
    v_mul_f32 v5, s62, v5
    v_fma_f32 v4, v4, v5, v4
    v_cvt_pk_bf16_f32 v4, v4, v4
    v_lshlrev_b32 v22, 16, v4
    v_mul_f32 v4, s60, v18
    v_fma_f32 v5, v18, s60, -v4
    v_fmac_f32 v5, s61, v18
    v_exp_f32 v4, v4
    v_mul_f32 v5, s62, v5
    v_fma_f32 v4, v4, v5, v4
    v_cvt_pk_bf16_f32 v4, v4, v4
    v_lshlrev_b32 v18, 16, v4
    v_mul_f32 v25, v18, v22
    v_mul_f32 v25, -1.0, v25
    v_mul_f32 v25, s60, v25
    v_mul_f32 v19, v19, v22
    v_mul_f32 v26, s63, v19
    v_fma_f32 v27, v19, s63, -v26
    v_fmac_f32 v27, s64, v19
    v_max3_f32 v4, abs(v20), abs(v21), abs(v23)
    v_max_f32 v4, v4, abs(v24)
    s_nop 1
    v_max_f32_dpp v4, v4, v4 row_shr:1 row_mask:0xf bank_mask:0xf
    s_nop 1
    v_max_f32_dpp v4, v4, v4 row_shr:2 row_mask:0xf bank_mask:0xf
    s_nop 1
    v_max_f32_dpp v4, v4, v4 row_shr:4 row_mask:0xf bank_mask:0xf
    s_nop 1
    v_max_f32_dpp v4, v4, v4 row_shr:8 row_mask:0xf bank_mask:0xf
    s_nop 1
    v_max_f32_dpp v4, v4, v4 row_bcast:15 row_mask:0xa bank_mask:0xf
    s_nop 1
    v_max_f32_dpp v4, v4, v4 row_bcast:31 row_mask:0xc bank_mask:0xf
    s_nop 1
    v_readlane_b32 s66, v4, 63
    s_nop 3
    v_mov_b32 v4, s66
    v_frexp_exp_i32_f32 v5, v4
    v_sub_u32 v6, 0, v5
    v_ldexp_f32 v20, v20, v6
    v_ldexp_f32 v21, v21, v6
    v_sub_f32 v21, 0, v21
    v_add_u32 v5, 8, v5
    v_ldexp_f32 v9, v22, v5
    v_mov_b32 v40, v20
    v_mov_b32 v41, v21
    v_mul_u32_u24 v46, 30096, v2
    v_lshl_add_u32 v46, v3, 2, v46
    v_add_u32 v46, 6144, v46
    v_and_b32 v4, 15, v1
    v_mul_u32_u24 v47, 528, v4
    v_lshrrev_b32 v5, 4, v1
    v_lshl_add_u32 v47, v5, 4, v47
    s_mul_i32 s26, s23, 30096
    s_mul_i32 s27, s24, 8448
    s_add_u32 s26, s26, s27
    s_add_u32 s26, s26, 6144
    v_add_u32 v47, s26, v47
    v_lshlrev_b32 v48, 8, v5
    v_lshl_add_u32 v48, v4, 2, v48
    s_mul_i32 s26, s23, 3072
    v_add_u32 v48, s26, v48
    s_mov_b32 s66, 0x3f800000
    v_mul_f32 v4, s66, v25
    v_exp_f32 v4, v4
    v_mul_f32 v5, s66, v26
    v_fract_f32 v5, v5
    v_fmac_f32 v5, s66, v27
    v_cos_f32 v6, v5
    v_sin_f32 v7, v5
    s_nop 0
    v_mul_f32 v28, v4, v6
    v_mul_f32 v29, v4, v7
    s_mov_b32 s66, 0x41800000
    v_mul_f32 v4, s66, v25
    v_exp_f32 v4, v4
    v_mul_f32 v5, s66, v26
    v_fract_f32 v5, v5
    v_fmac_f32 v5, s66, v27
    v_cos_f32 v6, v5
    v_sin_f32 v7, v5
    s_nop 0
    v_mul_f32 v30, v4, v6
    v_mul_f32 v31, -v4, v7
    v_mov_b32 v34, v20
    v_mov_b32 v35, v21
    v_mov_b32 v32, 1.0
    v_mov_b32 v33, 0
    v_cvt_pk_f16_f32 v44, v32, v33
    v_cvt_pk_f16_f32 v45, v34, v35
    v_pk_mul_f32 v[36:37], v[32:33], v[28:29] op_sel:[1,1] op_sel_hi:[1,0] neg_lo:[0,1]
    v_pk_mul_f32 v[38:39], v[34:35], v[30:31] op_sel:[1,1] op_sel_hi:[1,0] neg_lo:[0,1]
    ds_write_b32 v46, v44 offset:0
    ds_write_b32 v46, v45 offset:16896
    v_pk_fma_f32 v[32:33], v[32:33], v[28:29], v[36:37] op_sel_hi:[0,1,1]
    v_pk_fma_f32 v[34:35], v[34:35], v[30:31], v[38:39] op_sel_hi:[0,1,1]
    v_cvt_pk_f16_f32 v44, v32, v33
    v_cvt_pk_f16_f32 v45, v34, v35
    v_pk_mul_f32 v[36:37], v[32:33], v[28:29] op_sel:[1,1] op_sel_hi:[1,0] neg_lo:[0,1]
    v_pk_mul_f32 v[38:39], v[34:35], v[30:31] op_sel:[1,1] op_sel_hi:[1,0] neg_lo:[0,1]
    ds_write_b32 v46, v44 offset:528
    ds_write_b32 v46, v45 offset:17424
    v_pk_fma_f32 v[32:33], v[32:33], v[28:29], v[36:37] op_sel_hi:[0,1,1]
    v_pk_fma_f32 v[34:35], v[34:35], v[30:31], v[38:39] op_sel_hi:[0,1,1]
    v_cvt_pk_f16_f32 v44, v32, v33
    v_cvt_pk_f16_f32 v45, v34, v35
    v_pk_mul_f32 v[36:37], v[32:33], v[28:29] op_sel:[1,1] op_sel_hi:[1,0] neg_lo:[0,1]
    v_pk_mul_f32 v[38:39], v[34:35], v[30:31] op_sel:[1,1] op_sel_hi:[1,0] neg_lo:[0,1]
    ds_write_b32 v46, v44 offset:1056
    ds_write_b32 v46, v45 offset:17952
    v_pk_fma_f32 v[32:33], v[32:33], v[28:29], v[36:37] op_sel_hi:[0,1,1]
    v_pk_fma_f32 v[34:35], v[34:35], v[30:31], v[38:39] op_sel_hi:[0,1,1]
    v_cvt_pk_f16_f32 v44, v32, v33
    v_cvt_pk_f16_f32 v45, v34, v35
    v_pk_mul_f32 v[36:37], v[32:33], v[28:29] op_sel:[1,1] op_sel_hi:[1,0] neg_lo:[0,1]
    v_pk_mul_f32 v[38:39], v[34:35], v[30:31] op_sel:[1,1] op_sel_hi:[1,0] neg_lo:[0,1]
    ds_write_b32 v46, v44 offset:1584
    ds_write_b32 v46, v45 offset:18480
    v_pk_fma_f32 v[32:33], v[32:33], v[28:29], v[36:37] op_sel_hi:[0,1,1]
    v_pk_fma_f32 v[34:35], v[34:35], v[30:31], v[38:39] op_sel_hi:[0,1,1]
    v_cvt_pk_f16_f32 v44, v32, v33
    v_cvt_pk_f16_f32 v45, v34, v35
    v_pk_mul_f32 v[36:37], v[32:33], v[28:29] op_sel:[1,1] op_sel_hi:[1,0] neg_lo:[0,1]
    v_pk_mul_f32 v[38:39], v[34:35], v[30:31] op_sel:[1,1] op_sel_hi:[1,0] neg_lo:[0,1]
    ds_write_b32 v46, v44 offset:2112
    ds_write_b32 v46, v45 offset:19008
    v_pk_fma_f32 v[32:33], v[32:33], v[28:29], v[36:37] op_sel_hi:[0,1,1]
    v_pk_fma_f32 v[34:35], v[34:35], v[30:31], v[38:39] op_sel_hi:[0,1,1]
    v_cvt_pk_f16_f32 v44, v32, v33
    v_cvt_pk_f16_f32 v45, v34, v35
    v_pk_mul_f32 v[36:37], v[32:33], v[28:29] op_sel:[1,1] op_sel_hi:[1,0] neg_lo:[0,1]
    v_pk_mul_f32 v[38:39], v[34:35], v[30:31] op_sel:[1,1] op_sel_hi:[1,0] neg_lo:[0,1]
    ds_write_b32 v46, v44 offset:2640
    ds_write_b32 v46, v45 offset:19536
    v_pk_fma_f32 v[32:33], v[32:33], v[28:29], v[36:37] op_sel_hi:[0,1,1]
    v_pk_fma_f32 v[34:35], v[34:35], v[30:31], v[38:39] op_sel_hi:[0,1,1]
    v_cvt_pk_f16_f32 v44, v32, v33
    v_cvt_pk_f16_f32 v45, v34, v35
    v_pk_mul_f32 v[36:37], v[32:33], v[28:29] op_sel:[1,1] op_sel_hi:[1,0] neg_lo:[0,1]
    v_pk_mul_f32 v[38:39], v[34:35], v[30:31] op_sel:[1,1] op_sel_hi:[1,0] neg_lo:[0,1]
    ds_write_b32 v46, v44 offset:3168
    ds_write_b32 v46, v45 offset:20064
    v_pk_fma_f32 v[32:33], v[32:33], v[28:29], v[36:37] op_sel_hi:[0,1,1]
    v_pk_fma_f32 v[34:35], v[34:35], v[30:31], v[38:39] op_sel_hi:[0,1,1]
    v_cvt_pk_f16_f32 v44, v32, v33
    v_cvt_pk_f16_f32 v45, v34, v35
    v_pk_mul_f32 v[36:37], v[32:33], v[28:29] op_sel:[1,1] op_sel_hi:[1,0] neg_lo:[0,1]
    v_pk_mul_f32 v[38:39], v[34:35], v[30:31] op_sel:[1,1] op_sel_hi:[1,0] neg_lo:[0,1]
    ds_write_b32 v46, v44 offset:3696
    ds_write_b32 v46, v45 offset:20592
    v_pk_fma_f32 v[32:33], v[32:33], v[28:29], v[36:37] op_sel_hi:[0,1,1]
    v_pk_fma_f32 v[34:35], v[34:35], v[30:31], v[38:39] op_sel_hi:[0,1,1]
    v_cvt_pk_f16_f32 v44, v32, v33
    v_cvt_pk_f16_f32 v45, v34, v35
    v_pk_mul_f32 v[36:37], v[32:33], v[28:29] op_sel:[1,1] op_sel_hi:[1,0] neg_lo:[0,1]
    v_pk_mul_f32 v[38:39], v[34:35], v[30:31] op_sel:[1,1] op_sel_hi:[1,0] neg_lo:[0,1]
    ds_write_b32 v46, v44 offset:4224
    ds_write_b32 v46, v45 offset:21120
    v_pk_fma_f32 v[32:33], v[32:33], v[28:29], v[36:37] op_sel_hi:[0,1,1]
    v_pk_fma_f32 v[34:35], v[34:35], v[30:31], v[38:39] op_sel_hi:[0,1,1]
    v_cvt_pk_f16_f32 v44, v32, v33
    v_cvt_pk_f16_f32 v45, v34, v35
    v_pk_mul_f32 v[36:37], v[32:33], v[28:29] op_sel:[1,1] op_sel_hi:[1,0] neg_lo:[0,1]
    v_pk_mul_f32 v[38:39], v[34:35], v[30:31] op_sel:[1,1] op_sel_hi:[1,0] neg_lo:[0,1]
    ds_write_b32 v46, v44 offset:4752
    ds_write_b32 v46, v45 offset:21648
    v_pk_fma_f32 v[32:33], v[32:33], v[28:29], v[36:37] op_sel_hi:[0,1,1]
    v_pk_fma_f32 v[34:35], v[34:35], v[30:31], v[38:39] op_sel_hi:[0,1,1]
    v_cvt_pk_f16_f32 v44, v32, v33
    v_cvt_pk_f16_f32 v45, v34, v35
    v_pk_mul_f32 v[36:37], v[32:33], v[28:29] op_sel:[1,1] op_sel_hi:[1,0] neg_lo:[0,1]
    v_pk_mul_f32 v[38:39], v[34:35], v[30:31] op_sel:[1,1] op_sel_hi:[1,0] neg_lo:[0,1]
    ds_write_b32 v46, v44 offset:5280
    ds_write_b32 v46, v45 offset:22176
    v_pk_fma_f32 v[32:33], v[32:33], v[28:29], v[36:37] op_sel_hi:[0,1,1]
    v_pk_fma_f32 v[34:35], v[34:35], v[30:31], v[38:39] op_sel_hi:[0,1,1]
    v_cvt_pk_f16_f32 v44, v32, v33
    v_cvt_pk_f16_f32 v45, v34, v35
    v_pk_mul_f32 v[36:37], v[32:33], v[28:29] op_sel:[1,1] op_sel_hi:[1,0] neg_lo:[0,1]
    v_pk_mul_f32 v[38:39], v[34:35], v[30:31] op_sel:[1,1] op_sel_hi:[1,0] neg_lo:[0,1]
    ds_write_b32 v46, v44 offset:5808
    ds_write_b32 v46, v45 offset:22704
    v_pk_fma_f32 v[32:33], v[32:33], v[28:29], v[36:37] op_sel_hi:[0,1,1]
    v_pk_fma_f32 v[34:35], v[34:35], v[30:31], v[38:39] op_sel_hi:[0,1,1]
    v_cvt_pk_f16_f32 v44, v32, v33
    v_cvt_pk_f16_f32 v45, v34, v35
    v_pk_mul_f32 v[36:37], v[32:33], v[28:29] op_sel:[1,1] op_sel_hi:[1,0] neg_lo:[0,1]
    v_pk_mul_f32 v[38:39], v[34:35], v[30:31] op_sel:[1,1] op_sel_hi:[1,0] neg_lo:[0,1]
    ds_write_b32 v46, v44 offset:6336
    ds_write_b32 v46, v45 offset:23232
    v_pk_fma_f32 v[32:33], v[32:33], v[28:29], v[36:37] op_sel_hi:[0,1,1]
    v_pk_fma_f32 v[34:35], v[34:35], v[30:31], v[38:39] op_sel_hi:[0,1,1]
    v_cvt_pk_f16_f32 v44, v32, v33
    v_cvt_pk_f16_f32 v45, v34, v35
    v_pk_mul_f32 v[36:37], v[32:33], v[28:29] op_sel:[1,1] op_sel_hi:[1,0] neg_lo:[0,1]
    v_pk_mul_f32 v[38:39], v[34:35], v[30:31] op_sel:[1,1] op_sel_hi:[1,0] neg_lo:[0,1]
    ds_write_b32 v46, v44 offset:6864
    ds_write_b32 v46, v45 offset:23760
    v_pk_fma_f32 v[32:33], v[32:33], v[28:29], v[36:37] op_sel_hi:[0,1,1]
    v_pk_fma_f32 v[34:35], v[34:35], v[30:31], v[38:39] op_sel_hi:[0,1,1]
    v_cvt_pk_f16_f32 v44, v32, v33
    v_cvt_pk_f16_f32 v45, v34, v35
    v_pk_mul_f32 v[36:37], v[32:33], v[28:29] op_sel:[1,1] op_sel_hi:[1,0] neg_lo:[0,1]
    v_pk_mul_f32 v[38:39], v[34:35], v[30:31] op_sel:[1,1] op_sel_hi:[1,0] neg_lo:[0,1]
    ds_write_b32 v46, v44 offset:7392
    ds_write_b32 v46, v45 offset:24288
    v_pk_fma_f32 v[32:33], v[32:33], v[28:29], v[36:37] op_sel_hi:[0,1,1]
    v_pk_fma_f32 v[34:35], v[34:35], v[30:31], v[38:39] op_sel_hi:[0,1,1]
    v_cvt_pk_f16_f32 v44, v32, v33
    v_cvt_pk_f16_f32 v45, v34, v35
    ds_write_b32 v46, v44 offset:7920
    ds_write_b32 v46, v45 offset:24816
    v_pk_mul_f32 v[36:37], v[28:29], v[28:29] op_sel:[1,1] op_sel_hi:[1,0] neg_lo:[0,1]
    v_pk_fma_f32 v[28:29], v[28:29], v[28:29], v[36:37] op_sel_hi:[0,1,1]
    v_pk_mul_f32 v[38:39], v[30:31], v[30:31] op_sel:[1,1] op_sel_hi:[1,0] neg_lo:[0,1]
    v_pk_fma_f32 v[30:31], v[30:31], v[30:31], v[38:39] op_sel_hi:[0,1,1]
    s_mov_b32 s66, 0x43800000
    v_mul_f32 v4, s66, v25
    v_exp_f32 v4, v4
    v_mul_f32 v5, s66, v26
    v_fract_f32 v5, v5
    v_fmac_f32 v5, s66, v27
    v_cos_f32 v6, v5
    v_sin_f32 v7, v5
    s_nop 0
    v_mul_f32 v42, v4, v6
    v_mul_f32 v43, -v4, v7
    v_pk_mul_f32 v[38:39], v[40:41], v[42:43] op_sel:[1,1] op_sel_hi:[1,0] neg_lo:[0,1]
    v_pk_fma_f32 v[34:35], v[40:41], v[42:43], v[38:39] op_sel_hi:[0,1,1]
    v_mov_b32 v32, 1.0
    v_mov_b32 v33, 0
    v_cvt_pk_f16_f32 v44, v32, v33
    v_cvt_pk_f16_f32 v45, v34, v35
    v_pk_mul_f32 v[36:37], v[32:33], v[28:29] op_sel:[1,1] op_sel_hi:[1,0] neg_lo:[0,1]
    v_pk_mul_f32 v[38:39], v[34:35], v[30:31] op_sel:[1,1] op_sel_hi:[1,0] neg_lo:[0,1]
    ds_write_b32 v46, v44 offset:8448
    ds_write_b32 v46, v45 offset:25344
    v_pk_fma_f32 v[32:33], v[32:33], v[28:29], v[36:37] op_sel_hi:[0,1,1]
    v_pk_fma_f32 v[34:35], v[34:35], v[30:31], v[38:39] op_sel_hi:[0,1,1]
    v_cvt_pk_f16_f32 v44, v32, v33
    v_cvt_pk_f16_f32 v45, v34, v35
    v_pk_mul_f32 v[36:37], v[32:33], v[28:29] op_sel:[1,1] op_sel_hi:[1,0] neg_lo:[0,1]
    v_pk_mul_f32 v[38:39], v[34:35], v[30:31] op_sel:[1,1] op_sel_hi:[1,0] neg_lo:[0,1]
    ds_write_b32 v46, v44 offset:8976
    ds_write_b32 v46, v45 offset:25872
    v_pk_fma_f32 v[32:33], v[32:33], v[28:29], v[36:37] op_sel_hi:[0,1,1]
    v_pk_fma_f32 v[34:35], v[34:35], v[30:31], v[38:39] op_sel_hi:[0,1,1]
    v_cvt_pk_f16_f32 v44, v32, v33
    v_cvt_pk_f16_f32 v45, v34, v35
    v_pk_mul_f32 v[36:37], v[32:33], v[28:29] op_sel:[1,1] op_sel_hi:[1,0] neg_lo:[0,1]
    v_pk_mul_f32 v[38:39], v[34:35], v[30:31] op_sel:[1,1] op_sel_hi:[1,0] neg_lo:[0,1]
    ds_write_b32 v46, v44 offset:9504
    ds_write_b32 v46, v45 offset:26400
    v_pk_fma_f32 v[32:33], v[32:33], v[28:29], v[36:37] op_sel_hi:[0,1,1]
    v_pk_fma_f32 v[34:35], v[34:35], v[30:31], v[38:39] op_sel_hi:[0,1,1]
    v_cvt_pk_f16_f32 v44, v32, v33
    v_cvt_pk_f16_f32 v45, v34, v35
    v_pk_mul_f32 v[36:37], v[32:33], v[28:29] op_sel:[1,1] op_sel_hi:[1,0] neg_lo:[0,1]
    v_pk_mul_f32 v[38:39], v[34:35], v[30:31] op_sel:[1,1] op_sel_hi:[1,0] neg_lo:[0,1]
    ds_write_b32 v46, v44 offset:10032
    ds_write_b32 v46, v45 offset:26928
    v_pk_fma_f32 v[32:33], v[32:33], v[28:29], v[36:37] op_sel_hi:[0,1,1]
    v_pk_fma_f32 v[34:35], v[34:35], v[30:31], v[38:39] op_sel_hi:[0,1,1]
    v_cvt_pk_f16_f32 v44, v32, v33
    v_cvt_pk_f16_f32 v45, v34, v35
    v_pk_mul_f32 v[36:37], v[32:33], v[28:29] op_sel:[1,1] op_sel_hi:[1,0] neg_lo:[0,1]
    v_pk_mul_f32 v[38:39], v[34:35], v[30:31] op_sel:[1,1] op_sel_hi:[1,0] neg_lo:[0,1]
    ds_write_b32 v46, v44 offset:10560
    ds_write_b32 v46, v45 offset:27456
    v_pk_fma_f32 v[32:33], v[32:33], v[28:29], v[36:37] op_sel_hi:[0,1,1]
    v_pk_fma_f32 v[34:35], v[34:35], v[30:31], v[38:39] op_sel_hi:[0,1,1]
    v_cvt_pk_f16_f32 v44, v32, v33
    v_cvt_pk_f16_f32 v45, v34, v35
    v_pk_mul_f32 v[36:37], v[32:33], v[28:29] op_sel:[1,1] op_sel_hi:[1,0] neg_lo:[0,1]
    v_pk_mul_f32 v[38:39], v[34:35], v[30:31] op_sel:[1,1] op_sel_hi:[1,0] neg_lo:[0,1]
    ds_write_b32 v46, v44 offset:11088
    ds_write_b32 v46, v45 offset:27984
    v_pk_fma_f32 v[32:33], v[32:33], v[28:29], v[36:37] op_sel_hi:[0,1,1]
    v_pk_fma_f32 v[34:35], v[34:35], v[30:31], v[38:39] op_sel_hi:[0,1,1]
    v_cvt_pk_f16_f32 v44, v32, v33
    v_cvt_pk_f16_f32 v45, v34, v35
    v_pk_mul_f32 v[36:37], v[32:33], v[28:29] op_sel:[1,1] op_sel_hi:[1,0] neg_lo:[0,1]
    v_pk_mul_f32 v[38:39], v[34:35], v[30:31] op_sel:[1,1] op_sel_hi:[1,0] neg_lo:[0,1]
    ds_write_b32 v46, v44 offset:11616
    ds_write_b32 v46, v45 offset:28512
    v_pk_fma_f32 v[32:33], v[32:33], v[28:29], v[36:37] op_sel_hi:[0,1,1]
    v_pk_fma_f32 v[34:35], v[34:35], v[30:31], v[38:39] op_sel_hi:[0,1,1]
    v_cvt_pk_f16_f32 v44, v32, v33
    v_cvt_pk_f16_f32 v45, v34, v35
    v_pk_mul_f32 v[36:37], v[32:33], v[28:29] op_sel:[1,1] op_sel_hi:[1,0] neg_lo:[0,1]
    ds_write_b32 v46, v44 offset:12144
    ds_write_b32 v46, v45 offset:29040
    v_pk_fma_f32 v[32:33], v[32:33], v[28:29], v[36:37] op_sel_hi:[0,1,1]
    v_cvt_pk_f16_f32 v44, v32, v33
    v_pk_mul_f32 v[36:37], v[32:33], v[28:29] op_sel:[1,1] op_sel_hi:[1,0] neg_lo:[0,1]
    ds_write_b32 v46, v44 offset:12672
    v_pk_fma_f32 v[32:33], v[32:33], v[28:29], v[36:37] op_sel_hi:[0,1,1]
    v_cvt_pk_f16_f32 v44, v32, v33
    v_pk_mul_f32 v[36:37], v[32:33], v[28:29] op_sel:[1,1] op_sel_hi:[1,0] neg_lo:[0,1]
    ds_write_b32 v46, v44 offset:13200
    v_pk_fma_f32 v[32:33], v[32:33], v[28:29], v[36:37] op_sel_hi:[0,1,1]
    v_cvt_pk_f16_f32 v44, v32, v33
    v_pk_mul_f32 v[36:37], v[32:33], v[28:29] op_sel:[1,1] op_sel_hi:[1,0] neg_lo:[0,1]
    ds_write_b32 v46, v44 offset:13728
    v_pk_fma_f32 v[32:33], v[32:33], v[28:29], v[36:37] op_sel_hi:[0,1,1]
    v_cvt_pk_f16_f32 v44, v32, v33
    v_pk_mul_f32 v[36:37], v[32:33], v[28:29] op_sel:[1,1] op_sel_hi:[1,0] neg_lo:[0,1]
    ds_write_b32 v46, v44 offset:14256
    v_pk_fma_f32 v[32:33], v[32:33], v[28:29], v[36:37] op_sel_hi:[0,1,1]
    v_cvt_pk_f16_f32 v44, v32, v33
    v_pk_mul_f32 v[36:37], v[32:33], v[28:29] op_sel:[1,1] op_sel_hi:[1,0] neg_lo:[0,1]
    ds_write_b32 v46, v44 offset:14784
    v_pk_fma_f32 v[32:33], v[32:33], v[28:29], v[36:37] op_sel_hi:[0,1,1]
    v_cvt_pk_f16_f32 v44, v32, v33
    v_pk_mul_f32 v[36:37], v[32:33], v[28:29] op_sel:[1,1] op_sel_hi:[1,0] neg_lo:[0,1]
    ds_write_b32 v46, v44 offset:15312
    v_pk_fma_f32 v[32:33], v[32:33], v[28:29], v[36:37] op_sel_hi:[0,1,1]
    v_cvt_pk_f16_f32 v44, v32, v33
    v_pk_mul_f32 v[36:37], v[32:33], v[28:29] op_sel:[1,1] op_sel_hi:[1,0] neg_lo:[0,1]
    ds_write_b32 v46, v44 offset:15840
    v_pk_fma_f32 v[32:33], v[32:33], v[28:29], v[36:37] op_sel_hi:[0,1,1]
    v_cvt_pk_f16_f32 v44, v32, v33
    ds_write_b32 v46, v44 offset:16368
    s_waitcnt lgkmcnt(0)
    s_barrier
    v_mov_b32 v68, 0
    v_mov_b32 v69, 0
    v_mov_b32 v70, 0
    v_mov_b32 v71, 0
    ds_read_b128 v[52:55], v47 offset:16896
    ds_read_b128 v[60:63], v47 offset:0
    ds_read_b128 v[56:59], v47 offset:16960
    ds_read_b128 v[64:67], v47 offset:64
    s_waitcnt lgkmcnt(0)
    v_mfma_f32_16x16x32_f16 v[68:71], v[52:55], v[60:63], v[68:71]
    v_mfma_f32_16x16x32_f16 v[68:71], v[56:59], v[64:67], v[68:71]
    ds_read_b128 v[52:55], v47 offset:17024
    ds_read_b128 v[60:63], v47 offset:128
    ds_read_b128 v[56:59], v47 offset:17088
    ds_read_b128 v[64:67], v47 offset:192
    s_waitcnt lgkmcnt(0)
    v_mfma_f32_16x16x32_f16 v[68:71], v[52:55], v[60:63], v[68:71]
    v_mfma_f32_16x16x32_f16 v[68:71], v[56:59], v[64:67], v[68:71]
    ds_read_b128 v[52:55], v47 offset:17152
    ds_read_b128 v[60:63], v47 offset:256
    ds_read_b128 v[56:59], v47 offset:17216
    ds_read_b128 v[64:67], v47 offset:320
    s_waitcnt lgkmcnt(0)
    v_mfma_f32_16x16x32_f16 v[68:71], v[52:55], v[60:63], v[68:71]
    v_mfma_f32_16x16x32_f16 v[68:71], v[56:59], v[64:67], v[68:71]
    ds_read_b128 v[52:55], v47 offset:17280
    ds_read_b128 v[60:63], v47 offset:384
    ds_read_b128 v[56:59], v47 offset:17344
    ds_read_b128 v[64:67], v47 offset:448
    s_waitcnt lgkmcnt(0)
    v_mfma_f32_16x16x32_f16 v[68:71], v[52:55], v[60:63], v[68:71]
    v_mfma_f32_16x16x32_f16 v[68:71], v[56:59], v[64:67], v[68:71]
    s_nop 9
    s_lshl_b32 s26, s24, 9
    s_add_u32 s26, s26, 512
    s_cmp_eq_u32 s24, 0
    s_cselect_b32 s26, 0, s26
    v_add_u32 v4, s26, v48
    ds_write_b32 v4, v68 offset:0
    ds_write_b32 v4, v69 offset:64
    ds_write_b32 v4, v70 offset:128
    ds_write_b32 v4, v71 offset:192
    s_waitcnt lgkmcnt(0)
    s_barrier
    v_pk_mul_f32 v[36:37], v[28:29], v[28:29] op_sel:[1,1] op_sel_hi:[1,0] neg_lo:[0,1]
    v_pk_fma_f32 v[28:29], v[28:29], v[28:29], v[36:37] op_sel_hi:[0,1,1]
    v_pk_mul_f32 v[38:39], v[30:31], v[30:31] op_sel:[1,1] op_sel_hi:[1,0] neg_lo:[0,1]
    v_pk_fma_f32 v[30:31], v[30:31], v[30:31], v[38:39] op_sel_hi:[0,1,1]
    v_pk_mul_f32 v[36:37], v[42:43], v[42:43] op_sel:[1,1] op_sel_hi:[1,0] neg_lo:[0,1]
    v_pk_fma_f32 v[42:43], v[42:43], v[42:43], v[36:37] op_sel_hi:[0,1,1]
    v_pk_mul_f32 v[38:39], v[40:41], v[42:43] op_sel:[1,1] op_sel_hi:[1,0] neg_lo:[0,1]
    v_pk_fma_f32 v[34:35], v[40:41], v[42:43], v[38:39] op_sel_hi:[0,1,1]
    v_mov_b32 v32, 1.0
    v_mov_b32 v33, 0
    v_cvt_pk_f16_f32 v44, v32, v33
    v_cvt_pk_f16_f32 v45, v34, v35
    v_pk_mul_f32 v[36:37], v[32:33], v[28:29] op_sel:[1,1] op_sel_hi:[1,0] neg_lo:[0,1]
    v_pk_mul_f32 v[38:39], v[34:35], v[30:31] op_sel:[1,1] op_sel_hi:[1,0] neg_lo:[0,1]
    ds_write_b32 v46, v44 offset:0
    ds_write_b32 v46, v45 offset:16896
    v_pk_fma_f32 v[32:33], v[32:33], v[28:29], v[36:37] op_sel_hi:[0,1,1]
    v_pk_fma_f32 v[34:35], v[34:35], v[30:31], v[38:39] op_sel_hi:[0,1,1]
    v_cvt_pk_f16_f32 v44, v32, v33
    v_cvt_pk_f16_f32 v45, v34, v35
    v_pk_mul_f32 v[36:37], v[32:33], v[28:29] op_sel:[1,1] op_sel_hi:[1,0] neg_lo:[0,1]
    v_pk_mul_f32 v[38:39], v[34:35], v[30:31] op_sel:[1,1] op_sel_hi:[1,0] neg_lo:[0,1]
    ds_write_b32 v46, v44 offset:528
    ds_write_b32 v46, v45 offset:17424
    v_pk_fma_f32 v[32:33], v[32:33], v[28:29], v[36:37] op_sel_hi:[0,1,1]
    v_pk_fma_f32 v[34:35], v[34:35], v[30:31], v[38:39] op_sel_hi:[0,1,1]
    v_cvt_pk_f16_f32 v44, v32, v33
    v_cvt_pk_f16_f32 v45, v34, v35
    v_pk_mul_f32 v[36:37], v[32:33], v[28:29] op_sel:[1,1] op_sel_hi:[1,0] neg_lo:[0,1]
    v_pk_mul_f32 v[38:39], v[34:35], v[30:31] op_sel:[1,1] op_sel_hi:[1,0] neg_lo:[0,1]
    ds_write_b32 v46, v44 offset:1056
    ds_write_b32 v46, v45 offset:17952
    v_pk_fma_f32 v[32:33], v[32:33], v[28:29], v[36:37] op_sel_hi:[0,1,1]
    v_pk_fma_f32 v[34:35], v[34:35], v[30:31], v[38:39] op_sel_hi:[0,1,1]
    v_cvt_pk_f16_f32 v44, v32, v33
    v_cvt_pk_f16_f32 v45, v34, v35
    v_pk_mul_f32 v[36:37], v[32:33], v[28:29] op_sel:[1,1] op_sel_hi:[1,0] neg_lo:[0,1]
    v_pk_mul_f32 v[38:39], v[34:35], v[30:31] op_sel:[1,1] op_sel_hi:[1,0] neg_lo:[0,1]
    ds_write_b32 v46, v44 offset:1584
    ds_write_b32 v46, v45 offset:18480
    v_pk_fma_f32 v[32:33], v[32:33], v[28:29], v[36:37] op_sel_hi:[0,1,1]
    v_pk_fma_f32 v[34:35], v[34:35], v[30:31], v[38:39] op_sel_hi:[0,1,1]
    v_cvt_pk_f16_f32 v44, v32, v33
    v_cvt_pk_f16_f32 v45, v34, v35
    v_pk_mul_f32 v[36:37], v[32:33], v[28:29] op_sel:[1,1] op_sel_hi:[1,0] neg_lo:[0,1]
    v_pk_mul_f32 v[38:39], v[34:35], v[30:31] op_sel:[1,1] op_sel_hi:[1,0] neg_lo:[0,1]
    ds_write_b32 v46, v44 offset:2112
    ds_write_b32 v46, v45 offset:19008
    v_pk_fma_f32 v[32:33], v[32:33], v[28:29], v[36:37] op_sel_hi:[0,1,1]
    v_pk_fma_f32 v[34:35], v[34:35], v[30:31], v[38:39] op_sel_hi:[0,1,1]
    v_cvt_pk_f16_f32 v44, v32, v33
    v_cvt_pk_f16_f32 v45, v34, v35
    v_pk_mul_f32 v[36:37], v[32:33], v[28:29] op_sel:[1,1] op_sel_hi:[1,0] neg_lo:[0,1]
    v_pk_mul_f32 v[38:39], v[34:35], v[30:31] op_sel:[1,1] op_sel_hi:[1,0] neg_lo:[0,1]
    ds_write_b32 v46, v44 offset:2640
    ds_write_b32 v46, v45 offset:19536
    v_pk_fma_f32 v[32:33], v[32:33], v[28:29], v[36:37] op_sel_hi:[0,1,1]
    v_pk_fma_f32 v[34:35], v[34:35], v[30:31], v[38:39] op_sel_hi:[0,1,1]
    v_cvt_pk_f16_f32 v44, v32, v33
    v_cvt_pk_f16_f32 v45, v34, v35
    v_pk_mul_f32 v[36:37], v[32:33], v[28:29] op_sel:[1,1] op_sel_hi:[1,0] neg_lo:[0,1]
    v_pk_mul_f32 v[38:39], v[34:35], v[30:31] op_sel:[1,1] op_sel_hi:[1,0] neg_lo:[0,1]
    ds_write_b32 v46, v44 offset:3168
    ds_write_b32 v46, v45 offset:20064
    v_pk_fma_f32 v[32:33], v[32:33], v[28:29], v[36:37] op_sel_hi:[0,1,1]
    v_pk_fma_f32 v[34:35], v[34:35], v[30:31], v[38:39] op_sel_hi:[0,1,1]
    v_cvt_pk_f16_f32 v44, v32, v33
    v_cvt_pk_f16_f32 v45, v34, v35
    v_pk_mul_f32 v[36:37], v[32:33], v[28:29] op_sel:[1,1] op_sel_hi:[1,0] neg_lo:[0,1]
    ds_write_b32 v46, v44 offset:3696
    ds_write_b32 v46, v45 offset:20592
    v_pk_fma_f32 v[32:33], v[32:33], v[28:29], v[36:37] op_sel_hi:[0,1,1]
    v_cvt_pk_f16_f32 v44, v32, v33
    v_pk_mul_f32 v[36:37], v[32:33], v[28:29] op_sel:[1,1] op_sel_hi:[1,0] neg_lo:[0,1]
    ds_write_b32 v46, v44 offset:4224
    v_pk_fma_f32 v[32:33], v[32:33], v[28:29], v[36:37] op_sel_hi:[0,1,1]
    v_cvt_pk_f16_f32 v44, v32, v33
    v_pk_mul_f32 v[36:37], v[32:33], v[28:29] op_sel:[1,1] op_sel_hi:[1,0] neg_lo:[0,1]
    ds_write_b32 v46, v44 offset:4752
    v_pk_fma_f32 v[32:33], v[32:33], v[28:29], v[36:37] op_sel_hi:[0,1,1]
    v_cvt_pk_f16_f32 v44, v32, v33
    v_pk_mul_f32 v[36:37], v[32:33], v[28:29] op_sel:[1,1] op_sel_hi:[1,0] neg_lo:[0,1]
    ds_write_b32 v46, v44 offset:5280
    v_pk_fma_f32 v[32:33], v[32:33], v[28:29], v[36:37] op_sel_hi:[0,1,1]
    v_cvt_pk_f16_f32 v44, v32, v33
    v_pk_mul_f32 v[36:37], v[32:33], v[28:29] op_sel:[1,1] op_sel_hi:[1,0] neg_lo:[0,1]
    ds_write_b32 v46, v44 offset:5808
    v_pk_fma_f32 v[32:33], v[32:33], v[28:29], v[36:37] op_sel_hi:[0,1,1]
    v_cvt_pk_f16_f32 v44, v32, v33
    v_pk_mul_f32 v[36:37], v[32:33], v[28:29] op_sel:[1,1] op_sel_hi:[1,0] neg_lo:[0,1]
    ds_write_b32 v46, v44 offset:6336
    v_pk_fma_f32 v[32:33], v[32:33], v[28:29], v[36:37] op_sel_hi:[0,1,1]
    v_cvt_pk_f16_f32 v44, v32, v33
    v_pk_mul_f32 v[36:37], v[32:33], v[28:29] op_sel:[1,1] op_sel_hi:[1,0] neg_lo:[0,1]
    ds_write_b32 v46, v44 offset:6864
    v_pk_fma_f32 v[32:33], v[32:33], v[28:29], v[36:37] op_sel_hi:[0,1,1]
    v_cvt_pk_f16_f32 v44, v32, v33
    v_pk_mul_f32 v[36:37], v[32:33], v[28:29] op_sel:[1,1] op_sel_hi:[1,0] neg_lo:[0,1]
    ds_write_b32 v46, v44 offset:7392
    v_pk_fma_f32 v[32:33], v[32:33], v[28:29], v[36:37] op_sel_hi:[0,1,1]
    v_cvt_pk_f16_f32 v44, v32, v33
    ds_write_b32 v46, v44 offset:7920
    v_pk_mul_f32 v[36:37], v[28:29], v[28:29] op_sel:[1,1] op_sel_hi:[1,0] neg_lo:[0,1]
    v_pk_fma_f32 v[28:29], v[28:29], v[28:29], v[36:37] op_sel_hi:[0,1,1]
    v_pk_mul_f32 v[38:39], v[30:31], v[30:31] op_sel:[1,1] op_sel_hi:[1,0] neg_lo:[0,1]
    v_pk_fma_f32 v[30:31], v[30:31], v[30:31], v[38:39] op_sel_hi:[0,1,1]
    v_pk_mul_f32 v[36:37], v[42:43], v[42:43] op_sel:[1,1] op_sel_hi:[1,0] neg_lo:[0,1]
    v_pk_fma_f32 v[42:43], v[42:43], v[42:43], v[36:37] op_sel_hi:[0,1,1]
    v_pk_mul_f32 v[38:39], v[40:41], v[42:43] op_sel:[1,1] op_sel_hi:[1,0] neg_lo:[0,1]
    v_pk_fma_f32 v[34:35], v[40:41], v[42:43], v[38:39] op_sel_hi:[0,1,1]
    v_mov_b32 v32, 1.0
    v_mov_b32 v33, 0
    v_cvt_pk_f16_f32 v44, v32, v33
    v_cvt_pk_f16_f32 v45, v34, v35
    v_pk_mul_f32 v[36:37], v[32:33], v[28:29] op_sel:[1,1] op_sel_hi:[1,0] neg_lo:[0,1]
    v_pk_mul_f32 v[38:39], v[34:35], v[30:31] op_sel:[1,1] op_sel_hi:[1,0] neg_lo:[0,1]
    ds_write_b32 v46, v44 offset:8448
    ds_write_b32 v46, v45 offset:25344
    v_pk_fma_f32 v[32:33], v[32:33], v[28:29], v[36:37] op_sel_hi:[0,1,1]
    v_pk_fma_f32 v[34:35], v[34:35], v[30:31], v[38:39] op_sel_hi:[0,1,1]
    v_cvt_pk_f16_f32 v44, v32, v33
    v_cvt_pk_f16_f32 v45, v34, v35
    v_pk_mul_f32 v[36:37], v[32:33], v[28:29] op_sel:[1,1] op_sel_hi:[1,0] neg_lo:[0,1]
    v_pk_mul_f32 v[38:39], v[34:35], v[30:31] op_sel:[1,1] op_sel_hi:[1,0] neg_lo:[0,1]
    ds_write_b32 v46, v44 offset:8976
    ds_write_b32 v46, v45 offset:25872
    v_pk_fma_f32 v[32:33], v[32:33], v[28:29], v[36:37] op_sel_hi:[0,1,1]
    v_pk_fma_f32 v[34:35], v[34:35], v[30:31], v[38:39] op_sel_hi:[0,1,1]
    v_cvt_pk_f16_f32 v44, v32, v33
    v_cvt_pk_f16_f32 v45, v34, v35
    v_pk_mul_f32 v[36:37], v[32:33], v[28:29] op_sel:[1,1] op_sel_hi:[1,0] neg_lo:[0,1]
    v_pk_mul_f32 v[38:39], v[34:35], v[30:31] op_sel:[1,1] op_sel_hi:[1,0] neg_lo:[0,1]
    ds_write_b32 v46, v44 offset:9504
    ds_write_b32 v46, v45 offset:26400
    v_pk_fma_f32 v[32:33], v[32:33], v[28:29], v[36:37] op_sel_hi:[0,1,1]
    v_pk_fma_f32 v[34:35], v[34:35], v[30:31], v[38:39] op_sel_hi:[0,1,1]
    v_cvt_pk_f16_f32 v44, v32, v33
    v_cvt_pk_f16_f32 v45, v34, v35
    v_pk_mul_f32 v[36:37], v[32:33], v[28:29] op_sel:[1,1] op_sel_hi:[1,0] neg_lo:[0,1]
    v_pk_mul_f32 v[38:39], v[34:35], v[30:31] op_sel:[1,1] op_sel_hi:[1,0] neg_lo:[0,1]
    ds_write_b32 v46, v44 offset:10032
    ds_write_b32 v46, v45 offset:26928
    v_pk_fma_f32 v[32:33], v[32:33], v[28:29], v[36:37] op_sel_hi:[0,1,1]
    v_pk_fma_f32 v[34:35], v[34:35], v[30:31], v[38:39] op_sel_hi:[0,1,1]
    v_cvt_pk_f16_f32 v44, v32, v33
    v_cvt_pk_f16_f32 v45, v34, v35
    v_pk_mul_f32 v[36:37], v[32:33], v[28:29] op_sel:[1,1] op_sel_hi:[1,0] neg_lo:[0,1]
    v_pk_mul_f32 v[38:39], v[34:35], v[30:31] op_sel:[1,1] op_sel_hi:[1,0] neg_lo:[0,1]
    ds_write_b32 v46, v44 offset:10560
    ds_write_b32 v46, v45 offset:27456
    v_pk_fma_f32 v[32:33], v[32:33], v[28:29], v[36:37] op_sel_hi:[0,1,1]
    v_pk_fma_f32 v[34:35], v[34:35], v[30:31], v[38:39] op_sel_hi:[0,1,1]
    v_cvt_pk_f16_f32 v44, v32, v33
    v_cvt_pk_f16_f32 v45, v34, v35
    v_pk_mul_f32 v[36:37], v[32:33], v[28:29] op_sel:[1,1] op_sel_hi:[1,0] neg_lo:[0,1]
    v_pk_mul_f32 v[38:39], v[34:35], v[30:31] op_sel:[1,1] op_sel_hi:[1,0] neg_lo:[0,1]
    ds_write_b32 v46, v44 offset:11088
    ds_write_b32 v46, v45 offset:27984
    v_pk_fma_f32 v[32:33], v[32:33], v[28:29], v[36:37] op_sel_hi:[0,1,1]
    v_pk_fma_f32 v[34:35], v[34:35], v[30:31], v[38:39] op_sel_hi:[0,1,1]
    v_cvt_pk_f16_f32 v44, v32, v33
    v_cvt_pk_f16_f32 v45, v34, v35
    v_pk_mul_f32 v[36:37], v[32:33], v[28:29] op_sel:[1,1] op_sel_hi:[1,0] neg_lo:[0,1]
    v_pk_mul_f32 v[38:39], v[34:35], v[30:31] op_sel:[1,1] op_sel_hi:[1,0] neg_lo:[0,1]
    ds_write_b32 v46, v44 offset:11616
    ds_write_b32 v46, v45 offset:28512
    v_pk_fma_f32 v[32:33], v[32:33], v[28:29], v[36:37] op_sel_hi:[0,1,1]
    v_pk_fma_f32 v[34:35], v[34:35], v[30:31], v[38:39] op_sel_hi:[0,1,1]
    v_cvt_pk_f16_f32 v44, v32, v33
    v_cvt_pk_f16_f32 v45, v34, v35
    v_pk_mul_f32 v[36:37], v[32:33], v[28:29] op_sel:[1,1] op_sel_hi:[1,0] neg_lo:[0,1]
    v_pk_mul_f32 v[38:39], v[34:35], v[30:31] op_sel:[1,1] op_sel_hi:[1,0] neg_lo:[0,1]
    ds_write_b32 v46, v44 offset:12144
    ds_write_b32 v46, v45 offset:29040
    v_pk_fma_f32 v[32:33], v[32:33], v[28:29], v[36:37] op_sel_hi:[0,1,1]
    v_pk_fma_f32 v[34:35], v[34:35], v[30:31], v[38:39] op_sel_hi:[0,1,1]
    v_cvt_pk_f16_f32 v44, v32, v33
    v_cvt_pk_f16_f32 v45, v34, v35
    v_pk_mul_f32 v[36:37], v[32:33], v[28:29] op_sel:[1,1] op_sel_hi:[1,0] neg_lo:[0,1]
    ds_write_b32 v46, v44 offset:12672
    ds_write_b32 v46, v45 offset:29568
    v_pk_fma_f32 v[32:33], v[32:33], v[28:29], v[36:37] op_sel_hi:[0,1,1]
    v_cvt_pk_f16_f32 v44, v32, v33
    v_pk_mul_f32 v[36:37], v[32:33], v[28:29] op_sel:[1,1] op_sel_hi:[1,0] neg_lo:[0,1]
    ds_write_b32 v46, v44 offset:13200
    v_pk_fma_f32 v[32:33], v[32:33], v[28:29], v[36:37] op_sel_hi:[0,1,1]
    v_cvt_pk_f16_f32 v44, v32, v33
    v_pk_mul_f32 v[36:37], v[32:33], v[28:29] op_sel:[1,1] op_sel_hi:[1,0] neg_lo:[0,1]
    ds_write_b32 v46, v44 offset:13728
    v_pk_fma_f32 v[32:33], v[32:33], v[28:29], v[36:37] op_sel_hi:[0,1,1]
    v_cvt_pk_f16_f32 v44, v32, v33
    v_pk_mul_f32 v[36:37], v[32:33], v[28:29] op_sel:[1,1] op_sel_hi:[1,0] neg_lo:[0,1]
    ds_write_b32 v46, v44 offset:14256
    v_pk_fma_f32 v[32:33], v[32:33], v[28:29], v[36:37] op_sel_hi:[0,1,1]
    v_cvt_pk_f16_f32 v44, v32, v33
    v_pk_mul_f32 v[36:37], v[32:33], v[28:29] op_sel:[1,1] op_sel_hi:[1,0] neg_lo:[0,1]
    ds_write_b32 v46, v44 offset:14784
    v_pk_fma_f32 v[32:33], v[32:33], v[28:29], v[36:37] op_sel_hi:[0,1,1]
    v_cvt_pk_f16_f32 v44, v32, v33
    v_pk_mul_f32 v[36:37], v[32:33], v[28:29] op_sel:[1,1] op_sel_hi:[1,0] neg_lo:[0,1]
    ds_write_b32 v46, v44 offset:15312
    v_pk_fma_f32 v[32:33], v[32:33], v[28:29], v[36:37] op_sel_hi:[0,1,1]
    v_cvt_pk_f16_f32 v44, v32, v33
    v_pk_mul_f32 v[36:37], v[32:33], v[28:29] op_sel:[1,1] op_sel_hi:[1,0] neg_lo:[0,1]
    ds_write_b32 v46, v44 offset:15840
    v_pk_fma_f32 v[32:33], v[32:33], v[28:29], v[36:37] op_sel_hi:[0,1,1]
    v_cvt_pk_f16_f32 v44, v32, v33
    ds_write_b32 v46, v44 offset:16368
    s_waitcnt lgkmcnt(0)
    s_barrier
    v_mov_b32 v68, 0
    v_mov_b32 v69, 0
    v_mov_b32 v70, 0
    v_mov_b32 v71, 0
    ds_read_b128 v[52:55], v47 offset:16896
    ds_read_b128 v[60:63], v47 offset:0
    ds_read_b128 v[56:59], v47 offset:16960
    ds_read_b128 v[64:67], v47 offset:64
    s_waitcnt lgkmcnt(0)
    v_mfma_f32_16x16x32_f16 v[68:71], v[52:55], v[60:63], v[68:71]
    v_mfma_f32_16x16x32_f16 v[68:71], v[56:59], v[64:67], v[68:71]
    ds_read_b128 v[52:55], v47 offset:17024
    ds_read_b128 v[60:63], v47 offset:128
    ds_read_b128 v[56:59], v47 offset:17088
    ds_read_b128 v[64:67], v47 offset:192
    s_waitcnt lgkmcnt(0)
    v_mfma_f32_16x16x32_f16 v[68:71], v[52:55], v[60:63], v[68:71]
    v_mfma_f32_16x16x32_f16 v[68:71], v[56:59], v[64:67], v[68:71]
    ds_read_b128 v[52:55], v47 offset:17152
    ds_read_b128 v[60:63], v47 offset:256
    ds_read_b128 v[56:59], v47 offset:17216
    ds_read_b128 v[64:67], v47 offset:320
    s_waitcnt lgkmcnt(0)
    v_mfma_f32_16x16x32_f16 v[68:71], v[52:55], v[60:63], v[68:71]
    v_mfma_f32_16x16x32_f16 v[68:71], v[56:59], v[64:67], v[68:71]
    ds_read_b128 v[52:55], v47 offset:17280
    ds_read_b128 v[60:63], v47 offset:384
    ds_read_b128 v[56:59], v47 offset:17344
    ds_read_b128 v[64:67], v47 offset:448
    s_waitcnt lgkmcnt(0)
    v_mfma_f32_16x16x32_f16 v[68:71], v[52:55], v[60:63], v[68:71]
    v_mfma_f32_16x16x32_f16 v[68:71], v[56:59], v[64:67], v[68:71]
    s_nop 9
    s_lshl_b32 s26, s24, 9
    s_add_u32 s26, s26, 1536
    v_add_u32 v4, s26, v48
    ds_write_b32 v4, v68 offset:0
    ds_write_b32 v4, v69 offset:64
    ds_write_b32 v4, v70 offset:128
    ds_write_b32 v4, v71 offset:192
    s_waitcnt lgkmcnt(0)
    s_barrier
    s_cmp_eq_u32 s24, 0
    s_cbranch_scc1 L_s4_rw_29
    ds_write_b32 v4, v68 offset:0
    ds_write_b32 v4, v69 offset:64
    ds_write_b32 v4, v70 offset:128
    ds_write_b32 v4, v71 offset:192
L_s4_rw_29:
    s_waitcnt vmcnt(0)
    v_lshlrev_b32 v4, 16, v10
    v_and_b32 v18, 0x7fffffff, v4
    v_lshlrev_b32 v4, 16, v11
    v_max_f32 v18, v18, abs(v4)
    v_lshlrev_b32 v4, 16, v12
    v_max_f32 v18, v18, abs(v4)
    v_lshlrev_b32 v4, 16, v13
    v_max_f32 v18, v18, abs(v4)
    v_lshlrev_b32 v4, 16, v14
    v_max_f32 v18, v18, abs(v4)
    v_lshlrev_b32 v4, 16, v15
    v_max_f32 v18, v18, abs(v4)
    v_lshlrev_b32 v4, 16, v16
    v_max_f32 v18, v18, abs(v4)
    v_lshlrev_b32 v4, 16, v17
    v_max_f32 v18, v18, abs(v4)
    s_nop 1
    v_max_f32_dpp v18, v18, v18 row_shr:1 row_mask:0xf bank_mask:0xf
    s_nop 1
    v_max_f32_dpp v18, v18, v18 row_shr:2 row_mask:0xf bank_mask:0xf
    s_nop 1
    v_max_f32_dpp v18, v18, v18 row_shr:4 row_mask:0xf bank_mask:0xf
    s_nop 1
    v_max_f32_dpp v18, v18, v18 row_shr:8 row_mask:0xf bank_mask:0xf
    s_nop 1
    v_max_f32_dpp v18, v18, v18 row_bcast:15 row_mask:0xa bank_mask:0xf
    s_nop 1
    v_max_f32_dpp v18, v18, v18 row_bcast:31 row_mask:0xc bank_mask:0xf
    s_nop 1
    v_and_b32 v4, s65, v10
    v_and_b32 v19, 0x7fffffff, v4
    v_and_b32 v4, s65, v11
    v_max_f32 v19, v19, abs(v4)
    v_and_b32 v4, s65, v12
    v_max_f32 v19, v19, abs(v4)
    v_and_b32 v4, s65, v13
    v_max_f32 v19, v19, abs(v4)
    v_and_b32 v4, s65, v14
    v_max_f32 v19, v19, abs(v4)
    v_and_b32 v4, s65, v15
    v_max_f32 v19, v19, abs(v4)
    v_and_b32 v4, s65, v16
    v_max_f32 v19, v19, abs(v4)
    v_and_b32 v4, s65, v17
    v_max_f32 v19, v19, abs(v4)
    s_nop 1
    v_max_f32_dpp v19, v19, v19 row_shr:1 row_mask:0xf bank_mask:0xf
    s_nop 1
    v_max_f32_dpp v19, v19, v19 row_shr:2 row_mask:0xf bank_mask:0xf
    s_nop 1
    v_max_f32_dpp v19, v19, v19 row_shr:4 row_mask:0xf bank_mask:0xf
    s_nop 1
    v_max_f32_dpp v19, v19, v19 row_shr:8 row_mask:0xf bank_mask:0xf
    s_nop 1
    v_max_f32_dpp v19, v19, v19 row_bcast:15 row_mask:0xa bank_mask:0xf
    s_nop 1
    v_max_f32_dpp v19, v19, v19 row_bcast:31 row_mask:0xc bank_mask:0xf
    s_nop 1
    s_lshl_b32 s26, s22, 3
    s_add_u32 s26, s26, 73216
    v_mov_b32 v4, s26
    s_mov_b32 s68, 0
    s_mov_b32 s69, 0x80000000
    s_mov_b64 exec, s[68:69]
    ds_write_b64 v4, v[18:19]
    s_mov_b64 exec, -1
    v_mov_b32 v20, 0
    v_mov_b32 v21, 0
    v_mov_b32 v22, 0
    v_mov_b32 v23, 0
    v_lshlrev_b32 v4, 4, v0
    v_add_u32 v5, 21504, v4
    ds_write_b128 v5, v[20:23] offset:0
    ds_write_b128 v5, v[20:23] offset:4096
    ds_write_b128 v5, v[20:23] offset:8192
    ds_write_b128 v5, v[20:23] offset:12288
    ds_write_b128 v5, v[20:23] offset:16384
    ds_write_b128 v5, v[20:23] offset:20480
    ds_write_b128 v5, v[20:23] offset:24576
    ds_write_b128 v5, v[20:23] offset:28672
    ds_write_b128 v5, v[20:23] offset:32768
    v_cmp_gt_u32 vcc, 155, v0
    s_and_saveexec_b64 s[68:69], vcc
    ds_write_b128 v4, v[20:23] offset:6144
    ds_write_b128 v4, v[20:23] offset:13824
    s_mov_b64 exec, s[68:69]
    s_waitcnt lgkmcnt(0)
    s_barrier
    s_mul_i32 s26, s23, 3072
    v_lshlrev_b32 v4, 4, v3
    v_cvt_f32_u32 v24, v4
    v_lshlrev_b32 v41, 6, v3
    v_add_u32 v41, s26, v41
    v_cmp_gt_u32 vcc, 8, v3
    s_sub_u32 s26, s26, 68096
    v_add_f32 v4, 0x00000000, v24
    v_add_f32 v5, 0x3f800000, v24
    v_cvt_pk_bf16_f32 v4, v4, v5
    s_sub_u32 s27, s26, 0
    v_and_b32 v5, 0xffff, v4
    v_lshl_add_u32 v5, v5, 2, s27
    v_cndmask_b32 v5, v5, v41, vcc
    ds_read_b32 v25, v5 offset:0
    s_sub_u32 s27, s26, 4
    v_lshrrev_b32 v4, 16, v4
    v_lshl_add_u32 v4, v4, 2, s27
    v_cndmask_b32 v4, v4, v41, vcc
    ds_read_b32 v26, v4 offset:4
    v_add_f32 v4, 0x40000000, v24
    v_add_f32 v5, 0x40400000, v24
    v_cvt_pk_bf16_f32 v4, v4, v5
    s_sub_u32 s27, s26, 8
    v_and_b32 v5, 0xffff, v4
    v_lshl_add_u32 v5, v5, 2, s27
    v_cndmask_b32 v5, v5, v41, vcc
    ds_read_b32 v27, v5 offset:8
    s_sub_u32 s27, s26, 12
    v_lshrrev_b32 v4, 16, v4
    v_lshl_add_u32 v4, v4, 2, s27
    v_cndmask_b32 v4, v4, v41, vcc
    ds_read_b32 v28, v4 offset:12
    v_add_f32 v4, 0x40800000, v24
    v_add_f32 v5, 0x40a00000, v24
    v_cvt_pk_bf16_f32 v4, v4, v5
    s_sub_u32 s27, s26, 16
    v_and_b32 v5, 0xffff, v4
    v_lshl_add_u32 v5, v5, 2, s27
    v_cndmask_b32 v5, v5, v41, vcc
    ds_read_b32 v29, v5 offset:16
    s_sub_u32 s27, s26, 20
    v_lshrrev_b32 v4, 16, v4
    v_lshl_add_u32 v4, v4, 2, s27
    v_cndmask_b32 v4, v4, v41, vcc
    ds_read_b32 v30, v4 offset:20
    v_add_f32 v4, 0x40c00000, v24
    v_add_f32 v5, 0x40e00000, v24
    v_cvt_pk_bf16_f32 v4, v4, v5
    s_sub_u32 s27, s26, 24
    v_and_b32 v5, 0xffff, v4
    v_lshl_add_u32 v5, v5, 2, s27
    v_cndmask_b32 v5, v5, v41, vcc
    ds_read_b32 v31, v5 offset:24
    s_sub_u32 s27, s26, 28
    v_lshrrev_b32 v4, 16, v4
    v_lshl_add_u32 v4, v4, 2, s27
    v_cndmask_b32 v4, v4, v41, vcc
    ds_read_b32 v32, v4 offset:28
    v_add_f32 v4, 0x41000000, v24
    v_add_f32 v5, 0x41100000, v24
    v_cvt_pk_bf16_f32 v4, v4, v5
    s_sub_u32 s27, s26, 32
    v_and_b32 v5, 0xffff, v4
    v_lshl_add_u32 v5, v5, 2, s27
    v_cndmask_b32 v5, v5, v41, vcc
    ds_read_b32 v33, v5 offset:32
    s_sub_u32 s27, s26, 36
    v_lshrrev_b32 v4, 16, v4
    v_lshl_add_u32 v4, v4, 2, s27
    v_cndmask_b32 v4, v4, v41, vcc
    ds_read_b32 v34, v4 offset:36
    v_add_f32 v4, 0x41200000, v24
    v_add_f32 v5, 0x41300000, v24
    v_cvt_pk_bf16_f32 v4, v4, v5
    s_sub_u32 s27, s26, 40
    v_and_b32 v5, 0xffff, v4
    v_lshl_add_u32 v5, v5, 2, s27
    v_cndmask_b32 v5, v5, v41, vcc
    ds_read_b32 v35, v5 offset:40
    s_sub_u32 s27, s26, 44
    v_lshrrev_b32 v4, 16, v4
    v_lshl_add_u32 v4, v4, 2, s27
    v_cndmask_b32 v4, v4, v41, vcc
    ds_read_b32 v36, v4 offset:44
    v_add_f32 v4, 0x41400000, v24
    v_add_f32 v5, 0x41500000, v24
    v_cvt_pk_bf16_f32 v4, v4, v5
    s_sub_u32 s27, s26, 48
    v_and_b32 v5, 0xffff, v4
    v_lshl_add_u32 v5, v5, 2, s27
    v_cndmask_b32 v5, v5, v41, vcc
    ds_read_b32 v37, v5 offset:48
    s_sub_u32 s27, s26, 52
    v_lshrrev_b32 v4, 16, v4
    v_lshl_add_u32 v4, v4, 2, s27
    v_cndmask_b32 v4, v4, v41, vcc
    ds_read_b32 v38, v4 offset:52
    v_add_f32 v4, 0x41600000, v24
    v_add_f32 v5, 0x41700000, v24
    v_cvt_pk_bf16_f32 v4, v4, v5
    s_sub_u32 s27, s26, 56
    v_and_b32 v5, 0xffff, v4
    v_lshl_add_u32 v5, v5, 2, s27
    v_cndmask_b32 v5, v5, v41, vcc
    ds_read_b32 v39, v5 offset:56
    s_sub_u32 s27, s26, 60
    v_lshrrev_b32 v4, 16, v4
    v_lshl_add_u32 v4, v4, 2, s27
    v_cndmask_b32 v4, v4, v41, vcc
    ds_read_b32 v40, v4 offset:60
    v_mov_b32 v4, 73216
    ds_read_b128 v[44:47], v4
    ds_read_b128 v[48:51], v4 offset:16
    v_lshrrev_b32 v4, 1, v3
    v_mul_u32_u24 v52, 80, v4
    v_and_b32 v4, 1, v3
    v_lshl_add_u32 v52, v4, 5, v52
    v_mul_u32_u24 v4, 7680, v2
    v_add_u32 v52, v52, v4
    v_add_u32 v52, 8624, v52
    s_mov_b32 s66, 0x3c000000
    s_waitcnt lgkmcnt(0)
    v_mul_f32 v25, s66, v25
    v_mul_f32 v26, s66, v26
    v_cvt_pk_f16_f32 v56, v25, v26
    v_mul_f32 v27, s66, v27
    v_mul_f32 v28, s66, v28
    v_cvt_pk_f16_f32 v57, v27, v28
    v_mul_f32 v29, s66, v29
    v_mul_f32 v30, s66, v30
    v_cvt_pk_f16_f32 v58, v29, v30
    v_mul_f32 v31, s66, v31
    v_mul_f32 v32, s66, v32
    v_cvt_pk_f16_f32 v59, v31, v32
    v_mul_f32 v33, s66, v33
    v_mul_f32 v34, s66, v34
    v_cvt_pk_f16_f32 v60, v33, v34
    v_mul_f32 v35, s66, v35
    v_mul_f32 v36, s66, v36
    v_cvt_pk_f16_f32 v61, v35, v36
    v_mul_f32 v37, s66, v37
    v_mul_f32 v38, s66, v38
    v_cvt_pk_f16_f32 v62, v37, v38
    v_mul_f32 v39, s66, v39
    v_mul_f32 v40, s66, v40
    v_cvt_pk_f16_f32 v63, v39, v40
    ds_write_b128 v52, v[56:59]
    ds_write_b128 v52, v[60:63] offset:16
    v_max3_f32 v4, v44, v46, v48
    v_max_f32 v4, v4, v50
    v_frexp_exp_i32_f32 v4, v4
    v_sub_u32 v64, 15, v4
    v_max3_f32 v4, v45, v47, v49
    v_max_f32 v4, v4, v51
    v_frexp_exp_i32_f32 v4, v4
    v_sub_u32 v65, 15, v4
    v_cmp_eq_u32 vcc, 0, v2
    s_nop 1
    v_cndmask_b32 v4, v65, v64, vcc
    v_sub_u32 v4, 0, v4
    v_ldexp_f32 v9, v9, v4
    v_mov_b32 v66, v4
    v_lshlrev_b32 v4, 1, v0
    v_sub_u32 v67, 22014, v4
    v_lshlrev_b32 v6, 16, v10
    v_and_b32 v7, s65, v10
    v_ldexp_f32 v6, v6, v64
    v_ldexp_f32 v7, v7, v65
    v_cvt_pk_f16_f32 v6, v6, v7
    ds_write_b16 v67, v6 offset:3584
    ds_write_b16_d16_hi v67, v6 offset:21248
    ds_write_b16 v67, v6 offset:7998
    ds_write_b16_d16_hi v67, v6 offset:25662
    ds_write_b16 v67, v6 offset:12412
    ds_write_b16_d16_hi v67, v6 offset:30076
    ds_write_b16 v67, v6 offset:16826
    ds_write_b16_d16_hi v67, v6 offset:34490
    v_lshlrev_b32 v6, 16, v11
    v_and_b32 v7, s65, v11
    v_ldexp_f32 v6, v6, v64
    v_ldexp_f32 v7, v7, v65
    v_cvt_pk_f16_f32 v6, v6, v7
    ds_write_b16 v67, v6 offset:3072
    ds_write_b16_d16_hi v67, v6 offset:20736
    ds_write_b16 v67, v6 offset:7486
    ds_write_b16_d16_hi v67, v6 offset:25150
    ds_write_b16 v67, v6 offset:11900
    ds_write_b16_d16_hi v67, v6 offset:29564
    ds_write_b16 v67, v6 offset:16314
    ds_write_b16_d16_hi v67, v6 offset:33978
    v_lshlrev_b32 v6, 16, v12
    v_and_b32 v7, s65, v12
    v_ldexp_f32 v6, v6, v64
    v_ldexp_f32 v7, v7, v65
    v_cvt_pk_f16_f32 v6, v6, v7
    ds_write_b16 v67, v6 offset:2560
    ds_write_b16_d16_hi v67, v6 offset:20224
    ds_write_b16 v67, v6 offset:6974
    ds_write_b16_d16_hi v67, v6 offset:24638
    ds_write_b16 v67, v6 offset:11388
    ds_write_b16_d16_hi v67, v6 offset:29052
    ds_write_b16 v67, v6 offset:15802
    ds_write_b16_d16_hi v67, v6 offset:33466
    v_lshlrev_b32 v6, 16, v13
    v_and_b32 v7, s65, v13
    v_ldexp_f32 v6, v6, v64
    v_ldexp_f32 v7, v7, v65
    v_cvt_pk_f16_f32 v6, v6, v7
    ds_write_b16 v67, v6 offset:2048
    ds_write_b16_d16_hi v67, v6 offset:19712
    ds_write_b16 v67, v6 offset:6462
    ds_write_b16_d16_hi v67, v6 offset:24126
    ds_write_b16 v67, v6 offset:10876
    ds_write_b16_d16_hi v67, v6 offset:28540
    ds_write_b16 v67, v6 offset:15290
    ds_write_b16_d16_hi v67, v6 offset:32954
    v_lshlrev_b32 v6, 16, v14
    v_and_b32 v7, s65, v14
    v_ldexp_f32 v6, v6, v64
    v_ldexp_f32 v7, v7, v65
    v_cvt_pk_f16_f32 v6, v6, v7
    ds_write_b16 v67, v6 offset:1536
    ds_write_b16_d16_hi v67, v6 offset:19200
    ds_write_b16 v67, v6 offset:5950
    ds_write_b16_d16_hi v67, v6 offset:23614
    ds_write_b16 v67, v6 offset:10364
    ds_write_b16_d16_hi v67, v6 offset:28028
    ds_write_b16 v67, v6 offset:14778
    ds_write_b16_d16_hi v67, v6 offset:32442
    v_lshlrev_b32 v6, 16, v15
    v_and_b32 v7, s65, v15
    v_ldexp_f32 v6, v6, v64
    v_ldexp_f32 v7, v7, v65
    v_cvt_pk_f16_f32 v6, v6, v7
    ds_write_b16 v67, v6 offset:1024
    ds_write_b16_d16_hi v67, v6 offset:18688
    ds_write_b16 v67, v6 offset:5438
    ds_write_b16_d16_hi v67, v6 offset:23102
    ds_write_b16 v67, v6 offset:9852
    ds_write_b16_d16_hi v67, v6 offset:27516
    ds_write_b16 v67, v6 offset:14266
    ds_write_b16_d16_hi v67, v6 offset:31930
    v_lshlrev_b32 v6, 16, v16
    v_and_b32 v7, s65, v16
    v_ldexp_f32 v6, v6, v64
    v_ldexp_f32 v7, v7, v65
    v_cvt_pk_f16_f32 v6, v6, v7
    ds_write_b16 v67, v6 offset:512
    ds_write_b16_d16_hi v67, v6 offset:18176
    ds_write_b16 v67, v6 offset:4926
    ds_write_b16_d16_hi v67, v6 offset:22590
    ds_write_b16 v67, v6 offset:9340
    ds_write_b16_d16_hi v67, v6 offset:27004
    ds_write_b16 v67, v6 offset:13754
    ds_write_b16_d16_hi v67, v6 offset:31418
    v_lshlrev_b32 v6, 16, v17
    v_and_b32 v7, s65, v17
    v_ldexp_f32 v6, v6, v64
    v_ldexp_f32 v7, v7, v65
    v_cvt_pk_f16_f32 v6, v6, v7
    ds_write_b16 v67, v6 offset:0
    ds_write_b16_d16_hi v67, v6 offset:17664
    v_cmp_gt_u32 vcc, 255, v0
    s_and_saveexec_b64 s[68:69], vcc
    ds_write_b16 v67, v6 offset:4414
    ds_write_b16_d16_hi v67, v6 offset:22078
    s_mov_b64 exec, s[68:69]
    v_cmp_gt_u32 vcc, 254, v0
    s_and_saveexec_b64 s[68:69], vcc
    ds_write_b16 v67, v6 offset:8828
    ds_write_b16_d16_hi v67, v6 offset:26492
    s_mov_b64 exec, s[68:69]
    v_cmp_gt_u32 vcc, 253, v0
    s_and_saveexec_b64 s[68:69], vcc
    ds_write_b16 v67, v6 offset:13242
    ds_write_b16_d16_hi v67, v6 offset:30906
    s_mov_b64 exec, s[68:69]
    v_mov_b32 v10, v66
    s_waitcnt lgkmcnt(0)
    s_barrier
    v_and_b32 v18, 31, v1
    v_lshrrev_b32 v19, 5, v1
    v_mul_u32_u24 v20, 80, v18
    v_lshl_add_u32 v20, v19, 4, v20
    s_mul_i32 s26, s23, 7680
    s_add_u32 s26, s26, 8624
    v_add_u32 v20, s26, v20
    v_and_b32 v4, 3, v18
    v_sub_u32 v4, 3, v4
    v_mul_u32_u24 v21, 4416, v4
    v_lshrrev_b32 v4, 2, v18
    v_lshlrev_b32 v4, 3, v4
    v_sub_u32 v21, v21, v4
    v_lshl_add_u32 v21, v19, 4, v21
    s_mul_i32 s26, s23, 17664
    s_add_u32 s26, s26, 25592
    v_add_u32 v21, s26, v21
    v_mov_b32 v24, 0
    v_mov_b32 v40, 0
    v_mov_b32 v25, 0
    v_mov_b32 v41, 0
    v_mov_b32 v26, 0
    v_mov_b32 v42, 0
    v_mov_b32 v27, 0
    v_mov_b32 v43, 0
    v_mov_b32 v28, 0
    v_mov_b32 v44, 0
    v_mov_b32 v29, 0
    v_mov_b32 v45, 0
    v_mov_b32 v30, 0
    v_mov_b32 v46, 0
    v_mov_b32 v31, 0
    v_mov_b32 v47, 0
    v_mov_b32 v32, 0
    v_mov_b32 v48, 0
    v_mov_b32 v33, 0
    v_mov_b32 v49, 0
    v_mov_b32 v34, 0
    v_mov_b32 v50, 0
    v_mov_b32 v35, 0
    v_mov_b32 v51, 0
    v_mov_b32 v36, 0
    v_mov_b32 v52, 0
    v_mov_b32 v37, 0
    v_mov_b32 v53, 0
    v_mov_b32 v38, 0
    v_mov_b32 v54, 0
    v_mov_b32 v39, 0
    v_mov_b32 v55, 0
    s_cmp_eq_u32 s24, 1
    s_cbranch_scc1 L_s4_partB_30
    v_add_u32 v104, 2480, v20
    v_add_u32 v105, 4294967232, v21
    ds_read_b128 v[56:59], v104 offset:80
    ds_read_b128 v[60:63], v104 offset:112
    ds_read_b64 v[72:73], v105 offset:64
    ds_read_b64 v[74:75], v105 offset:72
    ds_read_b64 v[76:77], v105 offset:96
    ds_read_b64 v[78:79], v105 offset:104
    s_mov_b32 s67, 16
L_s4_conv_32:
    ds_read_b128 v[64:67], v104 offset:0
    ds_read_b128 v[68:71], v104 offset:32
    ds_read_b64 v[88:89], v105 offset:0
    ds_read_b64 v[90:91], v105 offset:8
    ds_read_b64 v[92:93], v105 offset:32
    ds_read_b64 v[94:95], v105 offset:40
    v_subrev_u32 v104, 160, v104
    v_subrev_u32 v105, 128, v105
    s_waitcnt lgkmcnt(6)
    v_mfma_f32_32x32x16_f16 v[40:55], v[72:75], v[56:59], v[40:55]
    v_mfma_f32_32x32x16_f16 v[40:55], v[76:79], v[60:63], v[40:55]
    ds_read_b128 v[56:59], v104 offset:80
    ds_read_b128 v[60:63], v104 offset:112
    ds_read_b64 v[72:73], v105 offset:64
    ds_read_b64 v[74:75], v105 offset:72
    ds_read_b64 v[76:77], v105 offset:96
    ds_read_b64 v[78:79], v105 offset:104
    s_waitcnt lgkmcnt(6)
    v_mfma_f32_32x32x16_f16 v[40:55], v[88:91], v[64:67], v[40:55]
    v_mfma_f32_32x32x16_f16 v[40:55], v[92:95], v[68:71], v[40:55]
    s_sub_u32 s67, s67, 1
    s_cmp_lg_u32 s67, 0
    s_cbranch_scc1 L_s4_conv_32
    s_waitcnt lgkmcnt(0)
    v_add_u32 v104, 4294967216, v20
    v_add_u32 v105, 4294965184, v21
    ds_read_b128 v[56:59], v104 offset:80
    ds_read_b128 v[60:63], v104 offset:112
    ds_read_b64 v[72:73], v105 offset:64
    ds_read_b64 v[74:75], v105 offset:72
    ds_read_b64 v[76:77], v105 offset:96
    ds_read_b64 v[78:79], v105 offset:104
    ds_read_b64 v[80:81], v105 offset:2112
    ds_read_b64 v[82:83], v105 offset:2120
    ds_read_b64 v[84:85], v105 offset:2144
    ds_read_b64 v[86:87], v105 offset:2152
    s_mov_b32 s67, 4
L_s4_conv_33:
    ds_read_b128 v[64:67], v104 offset:0
    ds_read_b128 v[68:71], v104 offset:32
    ds_read_b64 v[88:89], v105 offset:0
    ds_read_b64 v[90:91], v105 offset:8
    ds_read_b64 v[92:93], v105 offset:32
    ds_read_b64 v[94:95], v105 offset:40
    ds_read_b64 v[96:97], v105 offset:2048
    ds_read_b64 v[98:99], v105 offset:2056
    ds_read_b64 v[100:101], v105 offset:2080
    ds_read_b64 v[102:103], v105 offset:2088
    v_subrev_u32 v104, 160, v104
    v_subrev_u32 v105, 128, v105
    s_waitcnt lgkmcnt(10)
    v_mfma_f32_32x32x16_f16 v[40:55], v[72:75], v[56:59], v[40:55]
    v_mfma_f32_32x32x16_f16 v[24:39], v[80:83], v[56:59], v[24:39]
    v_mfma_f32_32x32x16_f16 v[40:55], v[76:79], v[60:63], v[40:55]
    v_mfma_f32_32x32x16_f16 v[24:39], v[84:87], v[60:63], v[24:39]
    ds_read_b128 v[56:59], v104 offset:80
    ds_read_b128 v[60:63], v104 offset:112
    ds_read_b64 v[72:73], v105 offset:64
    ds_read_b64 v[74:75], v105 offset:72
    ds_read_b64 v[76:77], v105 offset:96
    ds_read_b64 v[78:79], v105 offset:104
    ds_read_b64 v[80:81], v105 offset:2112
    ds_read_b64 v[82:83], v105 offset:2120
    ds_read_b64 v[84:85], v105 offset:2144
    ds_read_b64 v[86:87], v105 offset:2152
    s_waitcnt lgkmcnt(10)
    v_mfma_f32_32x32x16_f16 v[40:55], v[88:91], v[64:67], v[40:55]
    v_mfma_f32_32x32x16_f16 v[24:39], v[96:99], v[64:67], v[24:39]
    v_mfma_f32_32x32x16_f16 v[40:55], v[92:95], v[68:71], v[40:55]
    v_mfma_f32_32x32x16_f16 v[24:39], v[100:103], v[68:71], v[24:39]
    s_sub_u32 s67, s67, 1
    s_cmp_lg_u32 s67, 0
    s_cbranch_scc1 L_s4_conv_33
    s_waitcnt lgkmcnt(0)
    s_branch L_s4_join_31
L_s4_partB_30:
    v_add_u32 v104, 4294966576, v20
    v_add_u32 v105, 4294964672, v21
    ds_read_b128 v[56:59], v104 offset:80
    ds_read_b128 v[60:63], v104 offset:112
    ds_read_b64 v[72:73], v105 offset:64
    ds_read_b64 v[74:75], v105 offset:72
    ds_read_b64 v[76:77], v105 offset:96
    ds_read_b64 v[78:79], v105 offset:104
    ds_read_b64 v[80:81], v105 offset:2112
    ds_read_b64 v[82:83], v105 offset:2120
    ds_read_b64 v[84:85], v105 offset:2144
    ds_read_b64 v[86:87], v105 offset:2152
    s_mov_b32 s67, 12
L_s4_conv_34:
    ds_read_b128 v[64:67], v104 offset:0
    ds_read_b128 v[68:71], v104 offset:32
    ds_read_b64 v[88:89], v105 offset:0
    ds_read_b64 v[90:91], v105 offset:8
    ds_read_b64 v[92:93], v105 offset:32
    ds_read_b64 v[94:95], v105 offset:40
    ds_read_b64 v[96:97], v105 offset:2048
    ds_read_b64 v[98:99], v105 offset:2056
    ds_read_b64 v[100:101], v105 offset:2080
    ds_read_b64 v[102:103], v105 offset:2088
    v_subrev_u32 v104, 160, v104
    v_subrev_u32 v105, 128, v105
    s_waitcnt lgkmcnt(10)
    v_mfma_f32_32x32x16_f16 v[40:55], v[72:75], v[56:59], v[40:55]
    v_mfma_f32_32x32x16_f16 v[24:39], v[80:83], v[56:59], v[24:39]
    v_mfma_f32_32x32x16_f16 v[40:55], v[76:79], v[60:63], v[40:55]
    v_mfma_f32_32x32x16_f16 v[24:39], v[84:87], v[60:63], v[24:39]
    ds_read_b128 v[56:59], v104 offset:80
    ds_read_b128 v[60:63], v104 offset:112
    ds_read_b64 v[72:73], v105 offset:64
    ds_read_b64 v[74:75], v105 offset:72
    ds_read_b64 v[76:77], v105 offset:96
    ds_read_b64 v[78:79], v105 offset:104
    ds_read_b64 v[80:81], v105 offset:2112
    ds_read_b64 v[82:83], v105 offset:2120
    ds_read_b64 v[84:85], v105 offset:2144
    ds_read_b64 v[86:87], v105 offset:2152
    s_waitcnt lgkmcnt(10)
    v_mfma_f32_32x32x16_f16 v[40:55], v[88:91], v[64:67], v[40:55]
    v_mfma_f32_32x32x16_f16 v[24:39], v[96:99], v[64:67], v[24:39]
    v_mfma_f32_32x32x16_f16 v[40:55], v[92:95], v[68:71], v[40:55]
    v_mfma_f32_32x32x16_f16 v[24:39], v[100:103], v[68:71], v[24:39]
    s_sub_u32 s67, s67, 1
    s_cmp_lg_u32 s67, 0
    s_cbranch_scc1 L_s4_conv_34
    s_waitcnt lgkmcnt(0)
L_s4_join_31:
    s_nop 15
    v_lshlrev_b32 v106, 2, v1
    s_lshl_b32 s26, s22, 12
    s_add_u32 s26, s26, 56832
    v_add_u32 v6, s26, v106
    s_xor_b32 s27, s22, 1
    s_lshl_b32 s27, s27, 12
    s_add_u32 s27, s27, 56832
    v_add_u32 v7, s27, v106
    s_cmp_eq_u32 s24, 1
    s_cbranch_scc1 L_s4_xB_35
    ds_write_b32 v6, v24 offset:0
    ds_write_b32 v6, v25 offset:256
    ds_write_b32 v6, v26 offset:512
    ds_write_b32 v6, v27 offset:768
    ds_write_b32 v6, v28 offset:1024
    ds_write_b32 v6, v29 offset:1280
    ds_write_b32 v6, v30 offset:1536
    ds_write_b32 v6, v31 offset:1792
    ds_write_b32 v6, v32 offset:2048
    ds_write_b32 v6, v33 offset:2304
    ds_write_b32 v6, v34 offset:2560
    ds_write_b32 v6, v35 offset:2816
    ds_write_b32 v6, v36 offset:3072
    ds_write_b32 v6, v37 offset:3328
    ds_write_b32 v6, v38 offset:3584
    ds_write_b32 v6, v39 offset:3840
    s_branch L_s4_xJ_36
L_s4_xB_35:
    ds_write_b32 v6, v40 offset:0
    ds_write_b32 v6, v41 offset:256
    ds_write_b32 v6, v42 offset:512
    ds_write_b32 v6, v43 offset:768
    ds_write_b32 v6, v44 offset:1024
    ds_write_b32 v6, v45 offset:1280
    ds_write_b32 v6, v46 offset:1536
    ds_write_b32 v6, v47 offset:1792
    ds_write_b32 v6, v48 offset:2048
    ds_write_b32 v6, v49 offset:2304
    ds_write_b32 v6, v50 offset:2560
    ds_write_b32 v6, v51 offset:2816
    ds_write_b32 v6, v52 offset:3072
    ds_write_b32 v6, v53 offset:3328
    ds_write_b32 v6, v54 offset:3584
    ds_write_b32 v6, v55 offset:3840
    v_mov_b32 v40, v24
    v_mov_b32 v41, v25
    v_mov_b32 v42, v26
    v_mov_b32 v43, v27
    v_mov_b32 v44, v28
    v_mov_b32 v45, v29
    v_mov_b32 v46, v30
    v_mov_b32 v47, v31
    v_mov_b32 v48, v32
    v_mov_b32 v49, v33
    v_mov_b32 v50, v34
    v_mov_b32 v51, v35
    v_mov_b32 v52, v36
    v_mov_b32 v53, v37
    v_mov_b32 v54, v38
    v_mov_b32 v55, v39
L_s4_xJ_36:
    s_waitcnt lgkmcnt(0)
    s_barrier
    ds_read_b32 v24, v7 offset:0
    ds_read_b32 v25, v7 offset:256
    ds_read_b32 v26, v7 offset:512
    ds_read_b32 v27, v7 offset:768
    ds_read_b32 v28, v7 offset:1024
    ds_read_b32 v29, v7 offset:1280
    ds_read_b32 v30, v7 offset:1536
    ds_read_b32 v31, v7 offset:1792
    ds_read_b32 v32, v7 offset:2048
    ds_read_b32 v33, v7 offset:2304
    ds_read_b32 v34, v7 offset:2560
    ds_read_b32 v35, v7 offset:2816
    ds_read_b32 v36, v7 offset:3072
    ds_read_b32 v37, v7 offset:3328
    ds_read_b32 v38, v7 offset:3584
    ds_read_b32 v39, v7 offset:3840
    s_xor_b32 s26, s24, 1
    s_lshl_b32 s26, s26, 10
    v_lshlrev_b32 v107, 5, v18
    v_lshl_add_u32 v107, v19, 2, v107
    v_add_u32 v107, s26, v107
    s_mul_i32 s26, s23, 17664
    s_add_u32 s26, s26, 25544
    v_lshlrev_b32 v4, 1, v107
    v_sub_u32 v4, s26, v4
    ds_read_b64 v[72:73], v4 offset:48
    ds_read_b64 v[74:75], v4 offset:32
    ds_read_b64 v[76:77], v4 offset:16
    ds_read_b64 v[78:79], v4 offset:0
    v_lshlrev_b32 v6, 1, v107
    s_lshl_b32 s26, s23, 12
    s_add_u32 s26, s26, 6144
    v_add_u32 v6, s26, v6
    s_waitcnt lgkmcnt(0)
    v_cvt_f32_f16 v91, v72
    v_lshrrev_b32 v4, 16, v72
    v_cvt_f32_f16 v90, v4
    v_cvt_f32_f16 v89, v73
    v_lshrrev_b32 v4, 16, v73
    v_cvt_f32_f16 v88, v4
    v_add_f32 v40, v40, v24
    v_mul_f32 v40, v40, v9
    v_ldexp_f32 v88, v88, v10
    v_mul_f32 v88, v88, v8
    v_cvt_pk_bf16_f32 v4, v40, v88
    v_lshlrev_b32 v5, 16, v4
    v_and_b32 v4, s65, v4
    v_add_f32 v92, v4, v5
    v_add_f32 v41, v41, v25
    v_mul_f32 v41, v41, v9
    v_ldexp_f32 v89, v89, v10
    v_mul_f32 v89, v89, v8
    v_cvt_pk_bf16_f32 v4, v41, v89
    v_lshlrev_b32 v5, 16, v4
    v_and_b32 v4, s65, v4
    v_add_f32 v93, v4, v5
    v_add_f32 v42, v42, v26
    v_mul_f32 v42, v42, v9
    v_ldexp_f32 v90, v90, v10
    v_mul_f32 v90, v90, v8
    v_cvt_pk_bf16_f32 v4, v42, v90
    v_lshlrev_b32 v5, 16, v4
    v_and_b32 v4, s65, v4
    v_add_f32 v94, v4, v5
    v_add_f32 v43, v43, v27
    v_mul_f32 v43, v43, v9
    v_ldexp_f32 v91, v91, v10
    v_mul_f32 v91, v91, v8
    v_cvt_pk_bf16_f32 v4, v43, v91
    v_lshlrev_b32 v5, 16, v4
    v_and_b32 v4, s65, v4
    v_add_f32 v95, v4, v5
    v_cvt_pk_bf16_f32 v56, v92, v93
    v_cvt_pk_bf16_f32 v57, v94, v95
    ds_write_b64 v6, v[56:57] offset:0
    v_cvt_f32_f16 v91, v74
    v_lshrrev_b32 v4, 16, v74
    v_cvt_f32_f16 v90, v4
    v_cvt_f32_f16 v89, v75
    v_lshrrev_b32 v4, 16, v75
    v_cvt_f32_f16 v88, v4
    v_add_f32 v44, v44, v28
    v_mul_f32 v44, v44, v9
    v_ldexp_f32 v88, v88, v10
    v_mul_f32 v88, v88, v8
    v_cvt_pk_bf16_f32 v4, v44, v88
    v_lshlrev_b32 v5, 16, v4
    v_and_b32 v4, s65, v4
    v_add_f32 v92, v4, v5
    v_add_f32 v45, v45, v29
    v_mul_f32 v45, v45, v9
    v_ldexp_f32 v89, v89, v10
    v_mul_f32 v89, v89, v8
    v_cvt_pk_bf16_f32 v4, v45, v89
    v_lshlrev_b32 v5, 16, v4
    v_and_b32 v4, s65, v4
    v_add_f32 v93, v4, v5
    v_add_f32 v46, v46, v30
    v_mul_f32 v46, v46, v9
    v_ldexp_f32 v90, v90, v10
    v_mul_f32 v90, v90, v8
    v_cvt_pk_bf16_f32 v4, v46, v90
    v_lshlrev_b32 v5, 16, v4
    v_and_b32 v4, s65, v4
    v_add_f32 v94, v4, v5
    v_add_f32 v47, v47, v31
    v_mul_f32 v47, v47, v9
    v_ldexp_f32 v91, v91, v10
    v_mul_f32 v91, v91, v8
    v_cvt_pk_bf16_f32 v4, v47, v91
    v_lshlrev_b32 v5, 16, v4
    v_and_b32 v4, s65, v4
    v_add_f32 v95, v4, v5
    v_cvt_pk_bf16_f32 v58, v92, v93
    v_cvt_pk_bf16_f32 v59, v94, v95
    ds_write_b64 v6, v[58:59] offset:16
    v_cvt_f32_f16 v91, v76
    v_lshrrev_b32 v4, 16, v76
    v_cvt_f32_f16 v90, v4
    v_cvt_f32_f16 v89, v77
    v_lshrrev_b32 v4, 16, v77
    v_cvt_f32_f16 v88, v4
    v_add_f32 v48, v48, v32
    v_mul_f32 v48, v48, v9
    v_ldexp_f32 v88, v88, v10
    v_mul_f32 v88, v88, v8
    v_cvt_pk_bf16_f32 v4, v48, v88
    v_lshlrev_b32 v5, 16, v4
    v_and_b32 v4, s65, v4
    v_add_f32 v92, v4, v5
    v_add_f32 v49, v49, v33
    v_mul_f32 v49, v49, v9
    v_ldexp_f32 v89, v89, v10
    v_mul_f32 v89, v89, v8
    v_cvt_pk_bf16_f32 v4, v49, v89
    v_lshlrev_b32 v5, 16, v4
    v_and_b32 v4, s65, v4
    v_add_f32 v93, v4, v5
    v_add_f32 v50, v50, v34
    v_mul_f32 v50, v50, v9
    v_ldexp_f32 v90, v90, v10
    v_mul_f32 v90, v90, v8
    v_cvt_pk_bf16_f32 v4, v50, v90
    v_lshlrev_b32 v5, 16, v4
    v_and_b32 v4, s65, v4
    v_add_f32 v94, v4, v5
    v_add_f32 v51, v51, v35
    v_mul_f32 v51, v51, v9
    v_ldexp_f32 v91, v91, v10
    v_mul_f32 v91, v91, v8
    v_cvt_pk_bf16_f32 v4, v51, v91
    v_lshlrev_b32 v5, 16, v4
    v_and_b32 v4, s65, v4
    v_add_f32 v95, v4, v5
    v_cvt_pk_bf16_f32 v60, v92, v93
    v_cvt_pk_bf16_f32 v61, v94, v95
    ds_write_b64 v6, v[60:61] offset:32
    v_cvt_f32_f16 v91, v78
    v_lshrrev_b32 v4, 16, v78
    v_cvt_f32_f16 v90, v4
    v_cvt_f32_f16 v89, v79
    v_lshrrev_b32 v4, 16, v79
    v_cvt_f32_f16 v88, v4
    v_add_f32 v52, v52, v36
    v_mul_f32 v52, v52, v9
    v_ldexp_f32 v88, v88, v10
    v_mul_f32 v88, v88, v8
    v_cvt_pk_bf16_f32 v4, v52, v88
    v_lshlrev_b32 v5, 16, v4
    v_and_b32 v4, s65, v4
    v_add_f32 v92, v4, v5
    v_add_f32 v53, v53, v37
    v_mul_f32 v53, v53, v9
    v_ldexp_f32 v89, v89, v10
    v_mul_f32 v89, v89, v8
    v_cvt_pk_bf16_f32 v4, v53, v89
    v_lshlrev_b32 v5, 16, v4
    v_and_b32 v4, s65, v4
    v_add_f32 v93, v4, v5
    v_add_f32 v54, v54, v38
    v_mul_f32 v54, v54, v9
    v_ldexp_f32 v90, v90, v10
    v_mul_f32 v90, v90, v8
    v_cvt_pk_bf16_f32 v4, v54, v90
    v_lshlrev_b32 v5, 16, v4
    v_and_b32 v4, s65, v4
    v_add_f32 v94, v4, v5
    v_add_f32 v55, v55, v39
    v_mul_f32 v55, v55, v9
    v_ldexp_f32 v91, v91, v10
    v_mul_f32 v91, v91, v8
    v_cvt_pk_bf16_f32 v4, v55, v91
    v_lshlrev_b32 v5, 16, v4
    v_and_b32 v4, s65, v4
    v_add_f32 v95, v4, v5
    v_cvt_pk_bf16_f32 v62, v92, v93
    v_cvt_pk_bf16_f32 v63, v94, v95
    ds_write_b64 v6, v[62:63] offset:48
    s_waitcnt lgkmcnt(0)
    s_barrier
    v_lshlrev_b32 v4, 1, v0
    v_add_u32 v4, 6144, v4
    ds_read_u16 v24, v4 offset:0
    ds_read_u16 v32, v4 offset:4096
    ds_read_u16 v25, v4 offset:512
    ds_read_u16 v33, v4 offset:4608
    ds_read_u16 v26, v4 offset:1024
    ds_read_u16 v34, v4 offset:5120
    ds_read_u16 v27, v4 offset:1536
    ds_read_u16 v35, v4 offset:5632
    ds_read_u16 v28, v4 offset:2048
    ds_read_u16 v36, v4 offset:6144
    ds_read_u16 v29, v4 offset:2560
    ds_read_u16 v37, v4 offset:6656
    ds_read_u16 v30, v4 offset:3072
    ds_read_u16 v38, v4 offset:7168
    ds_read_u16 v31, v4 offset:3584
    ds_read_u16 v39, v4 offset:7680
    v_lshlrev_b32 v5, 11, v0
    s_lshl_b32 s26, s20, 1
    s_waitcnt lgkmcnt(0)
    v_lshl_or_b32 v24, v32, 16, v24
    buffer_store_dword v24, v5, s[56:59], s26 offen
    s_add_u32 s26, s26, 524288
    v_lshl_or_b32 v25, v33, 16, v25
    buffer_store_dword v25, v5, s[56:59], s26 offen
    s_add_u32 s26, s26, 524288
    v_lshl_or_b32 v26, v34, 16, v26
    buffer_store_dword v26, v5, s[56:59], s26 offen
    s_add_u32 s26, s26, 524288
    v_lshl_or_b32 v27, v35, 16, v27
    buffer_store_dword v27, v5, s[56:59], s26 offen
    s_add_u32 s26, s26, 524288
    v_lshl_or_b32 v28, v36, 16, v28
    buffer_store_dword v28, v5, s[56:59], s26 offen
    s_add_u32 s26, s26, 524288
    v_lshl_or_b32 v29, v37, 16, v29
    buffer_store_dword v29, v5, s[56:59], s26 offen
    s_add_u32 s26, s26, 524288
    v_lshl_or_b32 v30, v38, 16, v30
    buffer_store_dword v30, v5, s[56:59], s26 offen
    s_add_u32 s26, s26, 524288
    v_lshl_or_b32 v31, v39, 16, v31
    buffer_store_dword v31, v5, s[56:59], s26 offen
L_s4_end_28:
L_mid_exit_27:
    s_endpgm
.text
.globl fin_kernel
.p2align 8
.type fin_kernel,@function
fin_kernel:
    s_cmp_ge_u32 s2, 256
    s_cbranch_scc1 L_op_end_37
    s_load_dwordx2 s[4:5], s[0:1], 80
    s_load_dwordx2 s[6:7], s[0:1], 72
    s_load_dwordx2 s[8:9], s[0:1], 96
    s_and_b32 s10, s2, 31
    s_lshr_b32 s11, s2, 5
    v_mov_b32 v240, v0
    v_and_b32 v241, 63, v240
    v_lshrrev_b32 v242, 6, v240
    s_nop 0
    v_readfirstlane_b32 s12, v242
    s_waitcnt lgkmcnt(0)
    s_mov_b32 s16, s4
    s_and_b32 s17, s5, 0xffff
    s_mov_b32 s18, 4194304
    s_mov_b32 s19, 0x00020000
    s_mov_b32 s20, s6
    s_and_b32 s21, s7, 0xffff
    s_mov_b32 s22, 524288
    s_mov_b32 s23, 0x00020000
    s_mov_b32 s24, s8
    s_and_b32 s25, s9, 0xffff
    s_mov_b32 s26, 9437184
    s_mov_b32 s27, 0x00020000
    v_lshrrev_b32 v243, 3, v240
    v_lshlrev_b32 v243, 10, v243
    v_and_b32 v244, 7, v240
    v_lshl_add_u32 v243, v244, 4, v243
    s_lshl_b32 s13, s11, 7
    v_add_u32 v243, s13, v243
    s_mov_b32 s14, 0
    buffer_load_dwordx4 v[128:131], v243, s[20:23], s14 offen
    s_add_u32 s14, s14, 32768
    buffer_load_dwordx4 v[132:135], v243, s[20:23], s14 offen
    s_add_u32 s14, s14, 32768
    buffer_load_dwordx4 v[136:139], v243, s[20:23], s14 offen
    s_add_u32 s14, s14, 32768
    buffer_load_dwordx4 v[140:143], v243, s[20:23], s14 offen
    s_add_u32 s14, s14, 32768
    buffer_load_dwordx4 v[144:147], v243, s[20:23], s14 offen
    s_add_u32 s14, s14, 32768
    buffer_load_dwordx4 v[148:151], v243, s[20:23], s14 offen
    s_add_u32 s14, s14, 32768
    buffer_load_dwordx4 v[152:155], v243, s[20:23], s14 offen
    s_add_u32 s14, s14, 32768
    buffer_load_dwordx4 v[156:159], v243, s[20:23], s14 offen
    s_add_u32 s14, s14, 32768
    buffer_load_dwordx4 v[160:163], v243, s[20:23], s14 offen
    s_add_u32 s14, s14, 32768
    buffer_load_dwordx4 v[164:167], v243, s[20:23], s14 offen
    s_add_u32 s14, s14, 32768
    buffer_load_dwordx4 v[168:171], v243, s[20:23], s14 offen
    s_add_u32 s14, s14, 32768
    buffer_load_dwordx4 v[172:175], v243, s[20:23], s14 offen
    s_add_u32 s14, s14, 32768
    buffer_load_dwordx4 v[176:179], v243, s[20:23], s14 offen
    s_add_u32 s14, s14, 32768
    buffer_load_dwordx4 v[180:183], v243, s[20:23], s14 offen
    s_add_u32 s14, s14, 32768
    buffer_load_dwordx4 v[184:187], v243, s[20:23], s14 offen
    s_add_u32 s14, s14, 32768
    buffer_load_dwordx4 v[188:191], v243, s[20:23], s14 offen
    v_and_b32 v245, 31, v241
    v_lshrrev_b32 v246, 5, v241
    s_lshl_b32 s13, s10, 6
    s_lshr_b32 s15, s12, 1
    s_lshl_b32 s15, s15, 5
    s_add_u32 s13, s13, s15
    s_and_b32 s28, s12, 1
    v_add_u32 v247, s13, v245
    v_lshlrev_b32 v248, 15, v246
    v_lshl_add_u32 v248, v247, 4, v248
    s_mov_b32 s14, 6291456
    buffer_load_dwordx4 v[0:3], v248, s[24:27], s14 offen
    s_add_u32 s14, s14, 65536
    buffer_load_dwordx4 v[4:7], v248, s[24:27], s14 offen
    s_add_u32 s14, s14, 65536
    buffer_load_dwordx4 v[8:11], v248, s[24:27], s14 offen
    s_add_u32 s14, s14, 65536
    buffer_load_dwordx4 v[12:15], v248, s[24:27], s14 offen
    s_add_u32 s14, s14, 65536
    buffer_load_dwordx4 v[16:19], v248, s[24:27], s14 offen
    s_add_u32 s14, s14, 65536
    buffer_load_dwordx4 v[20:23], v248, s[24:27], s14 offen
    s_add_u32 s14, s14, 65536
    buffer_load_dwordx4 v[24:27], v248, s[24:27], s14 offen
    s_add_u32 s14, s14, 65536
    buffer_load_dwordx4 v[28:31], v248, s[24:27], s14 offen
    s_add_u32 s14, s14, 65536
    buffer_load_dwordx4 v[32:35], v248, s[24:27], s14 offen
    s_add_u32 s14, s14, 65536
    buffer_load_dwordx4 v[36:39], v248, s[24:27], s14 offen
    s_add_u32 s14, s14, 65536
    buffer_load_dwordx4 v[40:43], v248, s[24:27], s14 offen
    s_add_u32 s14, s14, 65536
    buffer_load_dwordx4 v[44:47], v248, s[24:27], s14 offen
    s_add_u32 s14, s14, 65536
    buffer_load_dwordx4 v[48:51], v248, s[24:27], s14 offen
    s_add_u32 s14, s14, 65536
    buffer_load_dwordx4 v[52:55], v248, s[24:27], s14 offen
    s_add_u32 s14, s14, 65536
    buffer_load_dwordx4 v[56:59], v248, s[24:27], s14 offen
    s_add_u32 s14, s14, 65536
    buffer_load_dwordx4 v[60:63], v248, s[24:27], s14 offen
    s_add_u32 s14, s14, 65536
    buffer_load_dwordx4 v[64:67], v248, s[24:27], s14 offen
    s_add_u32 s14, s14, 65536
    buffer_load_dwordx4 v[68:71], v248, s[24:27], s14 offen
    s_add_u32 s14, s14, 65536
    buffer_load_dwordx4 v[72:75], v248, s[24:27], s14 offen
    s_add_u32 s14, s14, 65536
    buffer_load_dwordx4 v[76:79], v248, s[24:27], s14 offen
    s_add_u32 s14, s14, 65536
    buffer_load_dwordx4 v[80:83], v248, s[24:27], s14 offen
    s_add_u32 s14, s14, 65536
    buffer_load_dwordx4 v[84:87], v248, s[24:27], s14 offen
    s_add_u32 s14, s14, 65536
    buffer_load_dwordx4 v[88:91], v248, s[24:27], s14 offen
    s_add_u32 s14, s14, 65536
    buffer_load_dwordx4 v[92:95], v248, s[24:27], s14 offen
    s_add_u32 s14, s14, 65536
    buffer_load_dwordx4 v[96:99], v248, s[24:27], s14 offen
    s_add_u32 s14, s14, 65536
    buffer_load_dwordx4 v[100:103], v248, s[24:27], s14 offen
    s_add_u32 s14, s14, 65536
    buffer_load_dwordx4 v[104:107], v248, s[24:27], s14 offen
    s_add_u32 s14, s14, 65536
    buffer_load_dwordx4 v[108:111], v248, s[24:27], s14 offen
    s_add_u32 s14, s14, 65536
    buffer_load_dwordx4 v[112:115], v248, s[24:27], s14 offen
    s_add_u32 s14, s14, 65536
    buffer_load_dwordx4 v[116:119], v248, s[24:27], s14 offen
    s_add_u32 s14, s14, 65536
    buffer_load_dwordx4 v[120:123], v248, s[24:27], s14 offen
    s_add_u32 s14, s14, 65536
    buffer_load_dwordx4 v[124:127], v248, s[24:27], s14 offen
    v_lshrrev_b32 v249, 3, v240
    v_lshlrev_b32 v249, 7, v249
    v_lshrrev_b32 v250, 2, v244
    v_bfe_u32 v251, v240, 4, 1
    v_xor_b32 v250, v250, v251
    v_lshl_add_u32 v249, v250, 6, v249
    v_and_b32 v250, 3, v240
    v_lshl_add_u32 v249, v250, 4, v249
    s_waitcnt vmcnt(47)
    ds_write_b128 v249, v[128:131] offset:0
    s_waitcnt vmcnt(46)
    ds_write_b128 v249, v[132:135] offset:4096
    s_waitcnt vmcnt(45)
    ds_write_b128 v249, v[136:139] offset:8192
    s_waitcnt vmcnt(44)
    ds_write_b128 v249, v[140:143] offset:12288
    s_waitcnt vmcnt(43)
    ds_write_b128 v249, v[144:147] offset:16384
    s_waitcnt vmcnt(42)
    ds_write_b128 v249, v[148:151] offset:20480
    s_waitcnt vmcnt(41)
    ds_write_b128 v249, v[152:155] offset:24576
    s_waitcnt vmcnt(40)
    ds_write_b128 v249, v[156:159] offset:28672
    s_waitcnt vmcnt(39)
    ds_write_b128 v249, v[160:163] offset:32768
    s_waitcnt vmcnt(38)
    ds_write_b128 v249, v[164:167] offset:36864
    s_waitcnt vmcnt(37)
    ds_write_b128 v249, v[168:171] offset:40960
    s_waitcnt vmcnt(36)
    ds_write_b128 v249, v[172:175] offset:45056
    s_waitcnt vmcnt(35)
    ds_write_b128 v249, v[176:179] offset:49152
    s_waitcnt vmcnt(34)
    ds_write_b128 v249, v[180:183] offset:53248
    s_waitcnt vmcnt(33)
    ds_write_b128 v249, v[184:187] offset:57344
    s_waitcnt vmcnt(32)
    ds_write_b128 v249, v[188:191] offset:61440
    v_bfe_u32 v250, v241, 2, 2
    v_lshl_add_u32 v251, v246, 2, v250
    v_lshlrev_b32 v251, 7, v251
    v_bfe_u32 v252, v241, 4, 1
    v_lshl_add_u32 v251, v252, 5, v251
    v_and_b32 v252, 3, v241
    v_lshl_add_u32 v251, v252, 3, v251
    v_lshrrev_b32 v252, 1, v250
    v_xor_b32 v252, s28, v252
    v_lshl_add_u32 v251, v252, 6, v251
    v_mov_b32 v192, 0
    v_mov_b32 v193, 0
    v_mov_b32 v194, 0
    v_mov_b32 v195, 0
    v_mov_b32 v196, 0
    v_mov_b32 v197, 0
    v_mov_b32 v198, 0
    v_mov_b32 v199, 0
    v_mov_b32 v200, 0
    v_mov_b32 v201, 0
    v_mov_b32 v202, 0
    v_mov_b32 v203, 0
    v_mov_b32 v204, 0
    v_mov_b32 v205, 0
    v_mov_b32 v206, 0
    v_mov_b32 v207, 0
    s_waitcnt lgkmcnt(0)
    s_barrier
    ds_read_b64_tr_b16 v[224:225], v251 offset:0
    ds_read_b64_tr_b16 v[226:227], v251 offset:1024
    ds_read_b64_tr_b16 v[228:229], v251 offset:2048
    ds_read_b64_tr_b16 v[230:231], v251 offset:3072
    s_waitcnt vmcnt(31) lgkmcnt(2)
    v_mfma_f32_32x32x16_bf16 v[192:207], v[224:227], v[0:3], v[192:207]
    ds_read_b64_tr_b16 v[224:225], v251 offset:4096
    ds_read_b64_tr_b16 v[226:227], v251 offset:5120
    s_waitcnt vmcnt(30) lgkmcnt(2)
    v_mfma_f32_32x32x16_bf16 v[192:207], v[228:231], v[4:7], v[192:207]
    ds_read_b64_tr_b16 v[228:229], v251 offset:6144
    ds_read_b64_tr_b16 v[230:231], v251 offset:7168
    s_waitcnt vmcnt(29) lgkmcnt(2)
    v_mfma_f32_32x32x16_bf16 v[192:207], v[224:227], v[8:11], v[192:207]
    ds_read_b64_tr_b16 v[224:225], v251 offset:8192
    ds_read_b64_tr_b16 v[226:227], v251 offset:9216
    s_waitcnt vmcnt(28) lgkmcnt(2)
    v_mfma_f32_32x32x16_bf16 v[192:207], v[228:231], v[12:15], v[192:207]
    ds_read_b64_tr_b16 v[228:229], v251 offset:10240
    ds_read_b64_tr_b16 v[230:231], v251 offset:11264
    s_waitcnt vmcnt(27) lgkmcnt(2)
    v_mfma_f32_32x32x16_bf16 v[192:207], v[224:227], v[16:19], v[192:207]
    ds_read_b64_tr_b16 v[224:225], v251 offset:12288
    ds_read_b64_tr_b16 v[226:227], v251 offset:13312
    s_waitcnt vmcnt(26) lgkmcnt(2)
    v_mfma_f32_32x32x16_bf16 v[192:207], v[228:231], v[20:23], v[192:207]
    ds_read_b64_tr_b16 v[228:229], v251 offset:14336
    ds_read_b64_tr_b16 v[230:231], v251 offset:15360
    s_waitcnt vmcnt(25) lgkmcnt(2)
    v_mfma_f32_32x32x16_bf16 v[192:207], v[224:227], v[24:27], v[192:207]
    ds_read_b64_tr_b16 v[224:225], v251 offset:16384
    ds_read_b64_tr_b16 v[226:227], v251 offset:17408
    s_waitcnt vmcnt(24) lgkmcnt(2)
    v_mfma_f32_32x32x16_bf16 v[192:207], v[228:231], v[28:31], v[192:207]
    ds_read_b64_tr_b16 v[228:229], v251 offset:18432
    ds_read_b64_tr_b16 v[230:231], v251 offset:19456
    s_waitcnt vmcnt(23) lgkmcnt(2)
    v_mfma_f32_32x32x16_bf16 v[192:207], v[224:227], v[32:35], v[192:207]
    ds_read_b64_tr_b16 v[224:225], v251 offset:20480
    ds_read_b64_tr_b16 v[226:227], v251 offset:21504
    s_waitcnt vmcnt(22) lgkmcnt(2)
    v_mfma_f32_32x32x16_bf16 v[192:207], v[228:231], v[36:39], v[192:207]
    ds_read_b64_tr_b16 v[228:229], v251 offset:22528
    ds_read_b64_tr_b16 v[230:231], v251 offset:23552
    s_waitcnt vmcnt(21) lgkmcnt(2)
    v_mfma_f32_32x32x16_bf16 v[192:207], v[224:227], v[40:43], v[192:207]
    ds_read_b64_tr_b16 v[224:225], v251 offset:24576
    ds_read_b64_tr_b16 v[226:227], v251 offset:25600
    s_waitcnt vmcnt(20) lgkmcnt(2)
    v_mfma_f32_32x32x16_bf16 v[192:207], v[228:231], v[44:47], v[192:207]
    ds_read_b64_tr_b16 v[228:229], v251 offset:26624
    ds_read_b64_tr_b16 v[230:231], v251 offset:27648
    s_waitcnt vmcnt(19) lgkmcnt(2)
    v_mfma_f32_32x32x16_bf16 v[192:207], v[224:227], v[48:51], v[192:207]
    ds_read_b64_tr_b16 v[224:225], v251 offset:28672
    ds_read_b64_tr_b16 v[226:227], v251 offset:29696
    s_waitcnt vmcnt(18) lgkmcnt(2)
    v_mfma_f32_32x32x16_bf16 v[192:207], v[228:231], v[52:55], v[192:207]
    ds_read_b64_tr_b16 v[228:229], v251 offset:30720
    ds_read_b64_tr_b16 v[230:231], v251 offset:31744
    s_waitcnt vmcnt(17) lgkmcnt(2)
    v_mfma_f32_32x32x16_bf16 v[192:207], v[224:227], v[56:59], v[192:207]
    ds_read_b64_tr_b16 v[224:225], v251 offset:32768
    ds_read_b64_tr_b16 v[226:227], v251 offset:33792
    s_waitcnt vmcnt(16) lgkmcnt(2)
    v_mfma_f32_32x32x16_bf16 v[192:207], v[228:231], v[60:63], v[192:207]
    ds_read_b64_tr_b16 v[228:229], v251 offset:34816
    ds_read_b64_tr_b16 v[230:231], v251 offset:35840
    s_waitcnt vmcnt(15) lgkmcnt(2)
    v_mfma_f32_32x32x16_bf16 v[192:207], v[224:227], v[64:67], v[192:207]
    ds_read_b64_tr_b16 v[224:225], v251 offset:36864
    ds_read_b64_tr_b16 v[226:227], v251 offset:37888
    s_waitcnt vmcnt(14) lgkmcnt(2)
    v_mfma_f32_32x32x16_bf16 v[192:207], v[228:231], v[68:71], v[192:207]
    ds_read_b64_tr_b16 v[228:229], v251 offset:38912
    ds_read_b64_tr_b16 v[230:231], v251 offset:39936
    s_waitcnt vmcnt(13) lgkmcnt(2)
    v_mfma_f32_32x32x16_bf16 v[192:207], v[224:227], v[72:75], v[192:207]
    ds_read_b64_tr_b16 v[224:225], v251 offset:40960
    ds_read_b64_tr_b16 v[226:227], v251 offset:41984
    s_waitcnt vmcnt(12) lgkmcnt(2)
    v_mfma_f32_32x32x16_bf16 v[192:207], v[228:231], v[76:79], v[192:207]
    ds_read_b64_tr_b16 v[228:229], v251 offset:43008
    ds_read_b64_tr_b16 v[230:231], v251 offset:44032
    s_waitcnt vmcnt(11) lgkmcnt(2)
    v_mfma_f32_32x32x16_bf16 v[192:207], v[224:227], v[80:83], v[192:207]
    ds_read_b64_tr_b16 v[224:225], v251 offset:45056
    ds_read_b64_tr_b16 v[226:227], v251 offset:46080
    s_waitcnt vmcnt(10) lgkmcnt(2)
    v_mfma_f32_32x32x16_bf16 v[192:207], v[228:231], v[84:87], v[192:207]
    ds_read_b64_tr_b16 v[228:229], v251 offset:47104
    ds_read_b64_tr_b16 v[230:231], v251 offset:48128
    s_waitcnt vmcnt(9) lgkmcnt(2)
    v_mfma_f32_32x32x16_bf16 v[192:207], v[224:227], v[88:91], v[192:207]
    ds_read_b64_tr_b16 v[224:225], v251 offset:49152
    ds_read_b64_tr_b16 v[226:227], v251 offset:50176
    s_waitcnt vmcnt(8) lgkmcnt(2)
    v_mfma_f32_32x32x16_bf16 v[192:207], v[228:231], v[92:95], v[192:207]
    ds_read_b64_tr_b16 v[228:229], v251 offset:51200
    ds_read_b64_tr_b16 v[230:231], v251 offset:52224
    s_waitcnt vmcnt(7) lgkmcnt(2)
    v_mfma_f32_32x32x16_bf16 v[192:207], v[224:227], v[96:99], v[192:207]
    ds_read_b64_tr_b16 v[224:225], v251 offset:53248
    ds_read_b64_tr_b16 v[226:227], v251 offset:54272
    s_waitcnt vmcnt(6) lgkmcnt(2)
    v_mfma_f32_32x32x16_bf16 v[192:207], v[228:231], v[100:103], v[192:207]
    ds_read_b64_tr_b16 v[228:229], v251 offset:55296
    ds_read_b64_tr_b16 v[230:231], v251 offset:56320
    s_waitcnt vmcnt(5) lgkmcnt(2)
    v_mfma_f32_32x32x16_bf16 v[192:207], v[224:227], v[104:107], v[192:207]
    ds_read_b64_tr_b16 v[224:225], v251 offset:57344
    ds_read_b64_tr_b16 v[226:227], v251 offset:58368
    s_waitcnt vmcnt(4) lgkmcnt(2)
    v_mfma_f32_32x32x16_bf16 v[192:207], v[228:231], v[108:111], v[192:207]
    ds_read_b64_tr_b16 v[228:229], v251 offset:59392
    ds_read_b64_tr_b16 v[230:231], v251 offset:60416
    s_waitcnt vmcnt(3) lgkmcnt(2)
    v_mfma_f32_32x32x16_bf16 v[192:207], v[224:227], v[112:115], v[192:207]
    ds_read_b64_tr_b16 v[224:225], v251 offset:61440
    ds_read_b64_tr_b16 v[226:227], v251 offset:62464
    s_waitcnt vmcnt(2) lgkmcnt(2)
    v_mfma_f32_32x32x16_bf16 v[192:207], v[228:231], v[116:119], v[192:207]
    ds_read_b64_tr_b16 v[228:229], v251 offset:63488
    ds_read_b64_tr_b16 v[230:231], v251 offset:64512
    s_waitcnt vmcnt(1) lgkmcnt(2)
    v_mfma_f32_32x32x16_bf16 v[192:207], v[224:227], v[120:123], v[192:207]
    s_waitcnt vmcnt(0) lgkmcnt(0)
    v_mfma_f32_32x32x16_bf16 v[192:207], v[228:231], v[124:127], v[192:207]
    s_nop 15
    s_lshl_b32 s30, s11, 7
    s_lshl_b32 s31, s28, 6
    s_add_u32 s30, s30, s31
    s_add_u32 s30, s30, 1024
    v_lshlrev_b32 v253, 11, v247
    v_lshl_add_u32 v253, v246, 3, v253
    v_cvt_pk_bf16_f32 v0, v192, v193
    v_cvt_pk_bf16_f32 v1, v194, v195
    buffer_store_dwordx2 v[0:1], v253, s[16:19], s30 offen offset:0
    v_cvt_pk_bf16_f32 v2, v196, v197
    v_cvt_pk_bf16_f32 v3, v198, v199
    buffer_store_dwordx2 v[2:3], v253, s[16:19], s30 offen offset:16
    v_cvt_pk_bf16_f32 v4, v200, v201
    v_cvt_pk_bf16_f32 v5, v202, v203
    buffer_store_dwordx2 v[4:5], v253, s[16:19], s30 offen offset:32
    v_cvt_pk_bf16_f32 v6, v204, v205
    v_cvt_pk_bf16_f32 v7, v206, v207
    buffer_store_dwordx2 v[6:7], v253, s[16:19], s30 offen offset:48
L_op_end_37:
    s_endpgm
.section .rodata,"a"
.p2align 6
.amdhsa_kernel qkv_kernel
  .amdhsa_next_free_vgpr 128
  .amdhsa_next_free_sgpr 102
  .amdhsa_accum_offset 128
  .amdhsa_group_segment_fixed_size 0
  .amdhsa_kernarg_size 104
  .amdhsa_user_sgpr_count 2
  .amdhsa_user_sgpr_kernarg_segment_ptr 1
  .amdhsa_system_sgpr_workgroup_id_x 1
  .amdhsa_float_denorm_mode_32 3
  .amdhsa_float_denorm_mode_16_64 3
.end_amdhsa_kernel
.section .rodata,"a"
.p2align 6
.amdhsa_kernel mid_kernel
  .amdhsa_next_free_vgpr 128
  .amdhsa_next_free_sgpr 102
  .amdhsa_accum_offset 128
  .amdhsa_group_segment_fixed_size 0
  .amdhsa_kernarg_size 104
  .amdhsa_user_sgpr_count 2
  .amdhsa_user_sgpr_kernarg_segment_ptr 1
  .amdhsa_system_sgpr_workgroup_id_x 1
  .amdhsa_float_denorm_mode_32 3
  .amdhsa_float_denorm_mode_16_64 3
.end_amdhsa_kernel
.section .rodata,"a"
.p2align 6
.amdhsa_kernel fin_kernel
  .amdhsa_next_free_vgpr 256
  .amdhsa_next_free_sgpr 102
  .amdhsa_accum_offset 256
  .amdhsa_group_segment_fixed_size 0
  .amdhsa_kernarg_size 104
  .amdhsa_user_sgpr_count 2
  .amdhsa_user_sgpr_kernarg_segment_ptr 1
  .amdhsa_system_sgpr_workgroup_id_x 1
  .amdhsa_float_denorm_mode_32 3
  .amdhsa_float_denorm_mode_16_64 3
.end_amdhsa_kernel
```
